```python
import torch

def _softmax(x, axis=-1):
    return torch.softmax(x, dim=axis)
def _gelu(x):
    return torch.nn.functional.gelu(x, approximate="tanh")
def _silu(x):
    return torch.nn.functional.silu(x)
def _sigmoid(x):
    return torch.sigmoid(x)
def _layernorm(x, axis=-1, eps=1e-5):
    m = x.mean(dim=axis, keepdim=True)
    v = x.var(dim=axis, keepdim=True, unbiased=False)
    return (x - m) / torch.sqrt(v + eps)
def _scatter_add(tgt, idx, src, axis=0):
    return tgt.clone().index_add_(axis, idx, src)
def _segment_sum(src, seg, n):
    out = torch.zeros((n,) + src.shape[1:], dtype=src.dtype)
    return out.index_add_(0, seg, src)
def _pad(x, pw):
    flat = tuple(v for pair in reversed(pw) for v in pair)
    return torch.nn.functional.pad(x, flat)

kernel_name = 'standalone__linear_kernel_performer__prompt'

def setup_inputs():

    _w = (lambda a: (lambda t: t.to(torch.bfloat16) if t.is_floating_point() else t)(torch.as_tensor(a)))
    B, H, S, D = 1, 32, 2048, 192
    M = D
    return {
        "q": _w((lambda *s: torch.randn(*s, dtype=torch.bfloat16) * 0.05)(B, H, S, D)),
        "k": _w((lambda *s: torch.randn(*s, dtype=torch.bfloat16) * 1.6)(B, H, S, D)),
        "v": _w((lambda *s: torch.randn(*s, dtype=torch.bfloat16) * 1.6)(B, H, S, D)),
        "proj": _w((lambda *s: torch.randn(*s, dtype=torch.bfloat16) * 1.6)(M, D)),
    }

def reference(q, k, v, proj):
    B, H, S, D = q.shape
    M = proj.shape[0]
    scale = D ** -0.25
    qs = q * scale
    ks = k * scale
    qw = torch.einsum("bhsd,md->bhsm", qs, proj)
    kw = torch.einsum("bhsd,md->bhsm", ks, proj)
    qn = torch.einsum("bhsd,bhsd->bhs", qs, qs)[..., None] * 0.5
    kn = torch.einsum("bhsd,bhsd->bhs", ks, ks)[..., None] * 0.5
    inv_sqrt_m = M ** -0.5
    phi_q = torch.exp(qw - qn) * inv_sqrt_m
    phi_k = torch.exp(kw - kn) * inv_sqrt_m
    kv = torch.einsum("bhsm,bhsd->bhmd", phi_k, v)
    ksum = torch.einsum("bhsm->bhm", phi_k)
    num = torch.einsum("bhsm,bhmd->bhsd", phi_q, kv)
    den = torch.einsum("bhsm,bhm->bhs", phi_q, ksum)[..., None] + 1e-6
    return num / den
```

```asm
; @launch grid=(256,1,1) block=(512,1,1) lds=137792
.amdgcn_target "amdgcn-amd-amdhsa--gfx950"
.text
.globl standalone__linear_kernel_performer__prompt_kernel
.p2align 8
.type standalone__linear_kernel_performer__prompt_kernel,@function
standalone__linear_kernel_performer__prompt_kernel:
  s_cmp_ge_u32 s2, 256
  s_cbranch_scc1 L_end
  s_load_dwordx8 s[8:15], s[0:1], 0
  s_load_dwordx4 s[16:19], s[0:1], 32
  s_load_dwordx2 s[20:21], s[0:1], 48
  v_lshrrev_b32 v1, 6, v0
  s_and_b32 s22, s2, 31
  s_lshr_b32 s23, s2, 5
  v_readfirstlane_b32 s24, v1
  v_and_b32 v1, 63, v0
  s_mul_i32 s25, s22, 786432
  s_mul_i32 s26, s23, 98304
  s_add_u32 s25, s25, s26
  s_mov_b32 s82, 12288
  s_mov_b32 s83, -24576
  s_lshl_b32 s57, s24, 2
  s_lshr_b32 s24, 0x75436210, s57
  s_and_b32 s24, s24, 15
  s_cmp_ge_u32 s24, 6
  s_waitcnt lgkmcnt(0)
  s_cbranch_scc0 L_cinit
  s_add_u32 s28, s10, s25
  s_addc_u32 s29, s11, 0
  s_and_b32 s29, s29, 0xffff
  s_mov_b32 s30, 98304
  s_mov_b32 s31, 0x20000
  s_sub_u32 s57, s24, 6
  s_lshl_b32 s52, s57, 1
  s_lshl_b32 s57, s57, 4
  v_lshrrev_b32 v7, 3, v1
  v_and_b32 v8, 7, v1
  v_add_u32 v9, s57, v7
  v_mul_u32_u24 v10, 384, v9
  v_lshl_add_u32 v2, v8, 4, v10
  s_mov_b32 s58, 0
  buffer_load_dwordx4 v[16:19], v2, s[28:31], s58 offen offset:0 nt
  buffer_load_dwordx4 v[20:23], v2, s[28:31], s58 offen offset:128 nt
  buffer_load_dwordx4 v[24:27], v2, s[28:31], s58 offen offset:256 nt
  buffer_load_dwordx4 v[28:31], v2, s[28:31], s58 offen offset:3072 nt
  buffer_load_dwordx4 v[32:35], v2, s[28:31], s58 offen offset:3200 nt
  buffer_load_dwordx4 v[36:39], v2, s[28:31], s58 offen offset:3328 nt
  s_mov_b32 s58, 12288
  buffer_load_dwordx4 v[40:43], v2, s[28:31], s58 offen offset:0 nt
  buffer_load_dwordx4 v[44:47], v2, s[28:31], s58 offen offset:128 nt
  buffer_load_dwordx4 v[48:51], v2, s[28:31], s58 offen offset:256 nt
  buffer_load_dwordx4 v[52:55], v2, s[28:31], s58 offen offset:3072 nt
  buffer_load_dwordx4 v[56:59], v2, s[28:31], s58 offen offset:3200 nt
  buffer_load_dwordx4 v[60:63], v2, s[28:31], s58 offen offset:3328 nt
  s_getpc_b64 s[90:91]
L_pcbase:
  s_sub_u32 s90, s90, L_pcbase - standalone__linear_kernel_performer__prompt_kernel
  s_subb_u32 s91, s91, 0
  s_lshr_b32 s57, s2, 3
  s_and_b32 s57, s57, 31
  s_lshl_b32 s57, s57, 10
  s_sub_u32 s58, s24, 6
  s_lshl_b32 s58, s58, 15
  s_add_u32 s57, s57, s58
  v_lshlrev_b32 v11, 4, v1
  v_add_u32 v11, s57, v11
  v_min_u32 v11, L_end - standalone__linear_kernel_performer__prompt_kernel - 16, v11
  global_load_dwordx4 v[240:243], v11, s[90:91]
  s_branch L_prod_rest
L_cinit:
  s_setprio 3
  v_lshrrev_b32 v160, 3, v1
  v_and_b32 v161, 7, v1
  v_mul_u32_u24 v162, 384, v160
  v_lshrrev_b32 v164, 1, v160
  v_xor_b32 v164, v164, v161
  v_lshl_add_u32 v164, v164, 4, v162
  v_xor_b32 v165, 64, v164
  s_mul_i32 s58, s24, 12288
  s_add_u32 s36, s14, s58
  s_addc_u32 s37, s15, 0
  s_and_b32 s37, s37, 0xffff
  s_mov_b32 s38, 12288
  s_mov_b32 s39, 0x20000
  s_add_u32 s59, s58, 24576
  s_add_u32 m0, s59, 0
  s_mov_b32 s60, 0
  buffer_load_dwordx4 v164, s[36:39], s60 offen lds
  s_add_u32 m0, s59, 1024
  s_mov_b32 s60, 3072
  buffer_load_dwordx4 v165, s[36:39], s60 offen lds
  s_add_u32 m0, s59, 2048
  s_mov_b32 s60, 6144
  buffer_load_dwordx4 v164, s[36:39], s60 offen lds
  s_add_u32 m0, s59, 3072
  s_mov_b32 s60, 9216
  buffer_load_dwordx4 v165, s[36:39], s60 offen lds
  s_add_u32 m0, s59, 4096
  s_mov_b32 s60, 128
  buffer_load_dwordx4 v164, s[36:39], s60 offen lds
  s_add_u32 m0, s59, 5120
  s_mov_b32 s60, 3200
  buffer_load_dwordx4 v165, s[36:39], s60 offen lds
  s_add_u32 m0, s59, 6144
  s_mov_b32 s60, 6272
  buffer_load_dwordx4 v164, s[36:39], s60 offen lds
  s_add_u32 m0, s59, 7168
  s_mov_b32 s60, 9344
  buffer_load_dwordx4 v165, s[36:39], s60 offen lds
  s_add_u32 m0, s59, 8192
  s_mov_b32 s60, 256
  buffer_load_dwordx4 v164, s[36:39], s60 offen lds
  s_add_u32 m0, s59, 9216
  s_mov_b32 s60, 3328
  buffer_load_dwordx4 v165, s[36:39], s60 offen lds
  s_add_u32 m0, s59, 10240
  s_mov_b32 s60, 6400
  buffer_load_dwordx4 v164, s[36:39], s60 offen lds
  s_add_u32 m0, s59, 11264
  s_mov_b32 s60, 9472
  buffer_load_dwordx4 v165, s[36:39], s60 offen lds
  s_setprio 0
  v_and_b32 v176, 31, v1
  v_lshrrev_b32 v177, 5, v1
  v_lshrrev_b32 v178, 1, v176
  v_and_b32 v178, 7, v178
  v_lshlrev_b32 v179, 7, v176
  v_add_u32 v179, 98304, v179
  v_add_u32 v180, 0, v177
  v_xor_b32 v180, v180, v178
  v_lshl_add_u32 v2, v180, 4, v179
  v_add_u32 v180, 2, v177
  v_xor_b32 v180, v180, v178
  v_lshl_add_u32 v3, v180, 4, v179
  v_add_u32 v180, 4, v177
  v_xor_b32 v180, v180, v178
  v_lshl_add_u32 v4, v180, 4, v179
  v_add_u32 v180, 6, v177
  v_xor_b32 v180, v180, v178
  v_lshl_add_u32 v5, v180, 4, v179
  v_lshlrev_b32 v11, 4, v1
  v_lshlrev_b32 v6, 4, v177
  v_add_u32 v6, 135168, v6
  v_and_b32 v178, 15, v1
  v_lshrrev_b32 v179, 2, v178
  v_lshl_add_u32 v179, v177, 2, v179
  v_lshlrev_b32 v179, 7, v179
  v_bfe_u32 v180, v1, 4, 1
  v_lshl_add_u32 v179, v180, 5, v179
  v_and_b32 v180, 3, v178
  v_lshl_add_u32 v179, v180, 3, v179
  v_bfe_u32 v180, v178, 3, 1
  v_lshl_add_u32 v7, v180, 6, v179
  v_xor_b32 v180, 1, v180
  v_lshl_add_u32 v8, v180, 6, v179
  v_mov_b32 v248, 0x3fb8aa3b
  v_mov_b32 v181, 137728
  v_mov_b32 v182, 0
  v_mov_b32 v183, 0
  ds_write_b64 v181, v[182:183]
  v_mov_b32 v252, 0x3f803f80
  v_mov_b32 v253, 0x3f803f80
  s_mov_b32 s55, 0
  s_mul_i32 s58, s24, 12288
  s_add_u32 s58, s58, -73728
  v_add_u32 v184, s58, v2
  v_add_u32 v185, s58, v3
  v_add_u32 v186, s58, v4
  v_add_u32 v187, s58, v5
  s_lshl_b32 s57, s22, 9
  s_add_u32 s57, s57, 30408704
  s_add_u32 s26, s20, s57
  s_addc_u32 s27, s21, 0
  s_waitcnt vmcnt(0)
  ds_read_b128 v[16:19], v184 offset:0
  ds_read_b128 v[20:23], v185 offset:0
  ds_read_b128 v[24:27], v186 offset:0
  ds_read_b128 v[28:31], v187 offset:0
  ds_read_b128 v[32:35], v184 offset:4096
  ds_read_b128 v[36:39], v185 offset:4096
  ds_read_b128 v[40:43], v186 offset:4096
  ds_read_b128 v[44:47], v187 offset:4096
  ds_read_b128 v[48:51], v184 offset:8192
  ds_read_b128 v[52:55], v185 offset:8192
  ds_read_b128 v[56:59], v186 offset:8192
  ds_read_b128 v[60:63], v187 offset:8192
  s_waitcnt lgkmcnt(0)
  s_barrier
  ds_read_b128 v[216:219], v2 offset:0
  ds_read_b128 v[220:223], v3 offset:0
  ds_read_b128 v[224:227], v4 offset:0
  ds_read_b128 v[228:231], v5 offset:0
  ds_read_b128 v[232:235], v2 offset:4096
  ds_read_b128 v[236:239], v3 offset:4096
  ds_read_b128 v[240:243], v4 offset:4096
  s_waitcnt lgkmcnt(4)
  v_mfma_f32_32x32x16_bf16 v[160:175], v[216:219], v[16:19], 0
  ds_read_b128 v[244:247], v5 offset:4096
  v_mov_b32 v12, 0
  v_mov_b32 v13, 0
  v_mov_b32 v14, 0
  v_mov_b32 v15, 0
  v_mov_b32 v64, 0
  v_mov_b32 v65, 0
  v_mov_b32 v66, 0
  v_mov_b32 v67, 0
  v_mfma_f32_32x32x16_bf16 v[160:175], v[220:223], v[20:23], v[160:175]
  ds_read_b128 v[216:219], v2 offset:8192
  v_mov_b32 v68, 0
  v_mov_b32 v69, 0
  v_mov_b32 v70, 0
  v_mov_b32 v71, 0
  v_mov_b32 v72, 0
  v_mov_b32 v73, 0
  v_mov_b32 v74, 0
  v_mov_b32 v75, 0
  v_mfma_f32_32x32x16_bf16 v[160:175], v[224:227], v[24:27], v[160:175]
  ds_read_b128 v[220:223], v3 offset:8192
  v_mov_b32 v76, 0
  v_mov_b32 v77, 0
  v_mov_b32 v78, 0
  v_mov_b32 v79, 0
  v_mov_b32 v80, 0
  v_mov_b32 v81, 0
  v_mov_b32 v82, 0
  v_mov_b32 v83, 0
  v_mov_b32 v84, 0
  s_waitcnt lgkmcnt(4)
  v_mfma_f32_32x32x16_bf16 v[160:175], v[228:231], v[28:31], v[160:175]
  ds_read_b128 v[224:227], v4 offset:8192
  v_mov_b32 v85, 0
  v_mov_b32 v86, 0
  v_mov_b32 v87, 0
  v_mov_b32 v88, 0
  v_mov_b32 v89, 0
  v_mov_b32 v90, 0
  v_mov_b32 v91, 0
  v_mov_b32 v92, 0
  v_mfma_f32_32x32x16_bf16 v[160:175], v[232:235], v[32:35], v[160:175]
  ds_read_b128 v[228:231], v5 offset:8192
  v_mov_b32 v93, 0
  v_mov_b32 v94, 0
  v_mov_b32 v95, 0
  v_mov_b32 v96, 0
  v_mov_b32 v97, 0
  v_mov_b32 v98, 0
  v_mov_b32 v99, 0
  v_mov_b32 v100, 0
  v_mfma_f32_32x32x16_bf16 v[160:175], v[236:239], v[36:39], v[160:175]
  v_mov_b32 v101, 0
  v_mov_b32 v102, 0
  v_mov_b32 v103, 0
  v_mov_b32 v104, 0
  v_mov_b32 v105, 0
  v_mov_b32 v106, 0
  v_mov_b32 v107, 0
  v_mov_b32 v108, 0
  v_mov_b32 v109, 0
  s_waitcnt lgkmcnt(3)
  v_mfma_f32_32x32x16_bf16 v[160:175], v[240:243], v[40:43], v[160:175]
  v_mov_b32 v110, 0
  v_mov_b32 v111, 0
  v_mov_b32 v112, 0
  v_mov_b32 v113, 0
  v_mov_b32 v114, 0
  v_mov_b32 v115, 0
  v_mov_b32 v116, 0
  v_mov_b32 v117, 0
  v_mfma_f32_32x32x16_bf16 v[160:175], v[244:247], v[44:47], v[160:175]
  v_mov_b32 v118, 0
  v_mov_b32 v119, 0
  v_mov_b32 v120, 0
  v_mov_b32 v121, 0
  v_mov_b32 v122, 0
  v_mov_b32 v123, 0
  v_mov_b32 v124, 0
  v_mov_b32 v125, 0
  v_mfma_f32_32x32x16_bf16 v[160:175], v[216:219], v[48:51], v[160:175]
  v_mov_b32 v126, 0
  v_mov_b32 v127, 0
  v_mov_b32 v128, 0
  v_mov_b32 v129, 0
  v_mov_b32 v130, 0
  v_mov_b32 v131, 0
  v_mov_b32 v132, 0
  v_mov_b32 v133, 0
  v_mov_b32 v134, 0
  s_waitcnt lgkmcnt(0)
  v_mfma_f32_32x32x16_bf16 v[160:175], v[220:223], v[52:55], v[160:175]
  v_mov_b32 v135, 0
  v_mov_b32 v136, 0
  v_mov_b32 v137, 0
  v_mov_b32 v138, 0
  v_mov_b32 v139, 0
  v_mov_b32 v140, 0
  v_mov_b32 v141, 0
  v_mov_b32 v142, 0
  v_mfma_f32_32x32x16_bf16 v[160:175], v[224:227], v[56:59], v[160:175]
  v_mov_b32 v143, 0
  v_mov_b32 v144, 0
  v_mov_b32 v145, 0
  v_mov_b32 v146, 0
  v_mov_b32 v147, 0
  v_mov_b32 v148, 0
  v_mov_b32 v149, 0
  v_mov_b32 v150, 0
  v_mfma_f32_32x32x16_bf16 v[160:175], v[228:231], v[60:63], v[160:175]
  v_mov_b32 v151, 0
  v_mov_b32 v152, 0
  v_mov_b32 v153, 0
  v_mov_b32 v154, 0
  v_mov_b32 v155, 0
  v_mov_b32 v156, 0
  v_mov_b32 v157, 0
  v_mov_b32 v158, 0
  v_mov_b32 v159, 0
  s_add_u32 s55, s55, 1
  s_cmp_eq_u32 s55, 3
  s_cselect_b32 s72, s83, s82
  s_cselect_b32 s55, 0, s55
  v_add_u32 v2, s72, v2
  v_add_u32 v3, s72, v3
  v_add_u32 v4, s72, v4
  v_add_u32 v5, s72, v5
  s_barrier
  s_mov_b32 s56, 0
  ds_read_b128 v[192:195], v6 offset:0
  ds_read_b128 v[196:199], v6 offset:32
  ds_read_b128 v[200:203], v6 offset:64
  ds_read_b128 v[204:207], v6 offset:96
  v_add_u32 v6, 128, v6
  ds_read_b128 v[216:219], v2 offset:0
  ds_read_b128 v[220:223], v3 offset:0
  ds_read_b128 v[224:227], v4 offset:0
  ds_read_b128 v[228:231], v5 offset:0
  ds_read_b128 v[232:235], v2 offset:4096
  ds_read_b128 v[236:239], v3 offset:4096
  ds_read_b128 v[240:243], v4 offset:4096
  s_barrier
  s_waitcnt lgkmcnt(4)
  v_mfma_f32_32x32x16_bf16 v[176:191], v[216:219], v[16:19], 0
  ds_read_b128 v[244:247], v5 offset:4096
  v_cvt_pk_bf16_f32 v160, 0, v160
  v_cvt_pk_bf16_f32 v161, 0, v161
  v_cvt_pk_bf16_f32 v162, 0, v162
  v_cvt_pk_bf16_f32 v163, 0, v163
  v_cvt_pk_bf16_f32 v164, 0, v164
  v_cvt_pk_bf16_f32 v165, 0, v165
  v_cvt_pk_bf16_f32 v166, 0, v166
  v_cvt_pk_bf16_f32 v167, 0, v167
  v_mfma_f32_32x32x16_bf16 v[176:191], v[220:223], v[20:23], v[176:191]
  ds_read_b128 v[216:219], v2 offset:8192
  v_cvt_pk_bf16_f32 v168, 0, v168
  v_cvt_pk_bf16_f32 v169, 0, v169
  v_cvt_pk_bf16_f32 v170, 0, v170
  v_cvt_pk_bf16_f32 v171, 0, v171
  v_cvt_pk_bf16_f32 v172, 0, v172
  v_cvt_pk_bf16_f32 v173, 0, v173
  v_cvt_pk_bf16_f32 v174, 0, v174
  v_cvt_pk_bf16_f32 v175, 0, v175
  v_mfma_f32_32x32x16_bf16 v[176:191], v[224:227], v[24:27], v[176:191]
  ds_read_b128 v[220:223], v3 offset:8192
  v_add_f32 v160, v160, v192
  v_add_f32 v161, v161, v193
  v_add_f32 v162, v162, v194
  v_add_f32 v163, v163, v195
  v_add_f32 v164, v164, v196
  v_add_f32 v165, v165, v197
  v_add_f32 v166, v166, v198
  s_waitcnt lgkmcnt(4)
  v_mfma_f32_32x32x16_bf16 v[176:191], v[228:231], v[28:31], v[176:191]
  ds_read_b128 v[224:227], v4 offset:8192
  v_add_f32 v167, v167, v199
  v_add_f32 v168, v168, v200
  v_add_f32 v169, v169, v201
  v_add_f32 v170, v170, v202
  v_add_f32 v171, v171, v203
  v_add_f32 v172, v172, v204
  v_add_f32 v173, v173, v205
  v_add_f32 v174, v174, v206
  v_add_f32 v175, v175, v207
  v_mfma_f32_32x32x16_bf16 v[176:191], v[232:235], v[32:35], v[176:191]
  ds_read_b128 v[228:231], v5 offset:8192
  ds_read_b128 v[192:195], v6 offset:0
  ds_read_b128 v[196:199], v6 offset:32
  ds_read_b128 v[200:203], v6 offset:64
  ds_read_b128 v[204:207], v6 offset:96
  v_add_u32 v6, 128, v6
  s_add_u32 s55, s55, 1
  s_cmp_eq_u32 s55, 3
  s_cselect_b32 s72, s83, s82
  s_cselect_b32 s55, 0, s55
  v_add_u32 v2, s72, v2
  v_add_u32 v3, s72, v3
  v_add_u32 v4, s72, v4
  v_add_u32 v5, s72, v5
  v_mfma_f32_32x32x16_bf16 v[176:191], v[236:239], v[36:39], v[176:191]
  ds_read_b64_tr_b16 v[232:233], v7 offset:0
  ds_read_b64_tr_b16 v[234:235], v7 offset:1024
  v_cvt_pk_bf16_f32 v160, 0, v160
  v_cvt_pk_bf16_f32 v161, 0, v161
  v_cvt_pk_bf16_f32 v162, 0, v162
  v_cvt_pk_bf16_f32 v163, 0, v163
  v_cvt_pk_bf16_f32 v164, 0, v164
  v_cvt_pk_bf16_f32 v165, 0, v165
  v_cvt_pk_bf16_f32 v166, 0, v166
  v_cvt_pk_bf16_f32 v167, 0, v167
  v_cvt_pk_bf16_f32 v168, 0, v168
  v_cvt_pk_bf16_f32 v169, 0, v169
  s_waitcnt lgkmcnt(9)
  v_mfma_f32_32x32x16_bf16 v[176:191], v[240:243], v[40:43], v[176:191]
  ds_read_b64_tr_b16 v[236:237], v8 offset:0
  ds_read_b64_tr_b16 v[238:239], v8 offset:1024
  v_cvt_pk_bf16_f32 v170, 0, v170
  v_cvt_pk_bf16_f32 v171, 0, v171
  v_cvt_pk_bf16_f32 v172, 0, v172
  v_cvt_pk_bf16_f32 v173, 0, v173
  v_cvt_pk_bf16_f32 v174, 0, v174
  v_cvt_pk_bf16_f32 v175, 0, v175
  v_fma_f32 v160, v160, v248, -4.0
  v_fma_f32 v161, v161, v248, -4.0
  v_fma_f32 v162, v162, v248, -4.0
  v_fma_f32 v163, v163, v248, -4.0
  v_mfma_f32_32x32x16_bf16 v[176:191], v[244:247], v[44:47], v[176:191]
  ds_read_b64_tr_b16 v[240:241], v7 offset:4096
  ds_read_b64_tr_b16 v[242:243], v7 offset:5120
  v_fma_f32 v164, v164, v248, -4.0
  v_fma_f32 v165, v165, v248, -4.0
  v_fma_f32 v166, v166, v248, -4.0
  v_fma_f32 v167, v167, v248, -4.0
  v_fma_f32 v168, v168, v248, -4.0
  v_fma_f32 v169, v169, v248, -4.0
  v_fma_f32 v170, v170, v248, -4.0
  v_fma_f32 v171, v171, v248, -4.0
  v_fma_f32 v172, v172, v248, -4.0
  v_fma_f32 v173, v173, v248, -4.0
  v_mfma_f32_32x32x16_bf16 v[176:191], v[216:219], v[48:51], v[176:191]
  ds_read_b64_tr_b16 v[244:245], v8 offset:4096
  ds_read_b64_tr_b16 v[246:247], v8 offset:5120
  v_fma_f32 v174, v174, v248, -4.0
  v_fma_f32 v175, v175, v248, -4.0
  v_exp_f32 v160, v160
  v_exp_f32 v161, v161
  v_exp_f32 v162, v162
  v_exp_f32 v163, v163
  v_exp_f32 v164, v164
  v_exp_f32 v165, v165
  v_exp_f32 v166, v166
  v_exp_f32 v167, v167
  v_exp_f32 v168, v168
  s_waitcnt lgkmcnt(12)
  v_mfma_f32_32x32x16_bf16 v[176:191], v[220:223], v[52:55], v[176:191]
  ds_read_b64_tr_b16 v[216:217], v7 offset:8192
  ds_read_b64_tr_b16 v[218:219], v7 offset:9216
  v_exp_f32 v169, v169
  v_exp_f32 v170, v170
  v_exp_f32 v171, v171
  v_exp_f32 v172, v172
  v_exp_f32 v173, v173
  v_exp_f32 v174, v174
  v_exp_f32 v175, v175
  v_add_f32 v12, v12, v160
  v_add_f32 v13, v13, v161
  v_add_f32 v12, v12, v162
  v_mfma_f32_32x32x16_bf16 v[176:191], v[224:227], v[56:59], v[176:191]
  ds_read_b64_tr_b16 v[220:221], v8 offset:8192
  ds_read_b64_tr_b16 v[222:223], v8 offset:9216
  v_add_f32 v13, v13, v163
  v_add_f32 v12, v12, v164
  v_add_f32 v13, v13, v165
  v_add_f32 v12, v12, v166
  v_add_f32 v13, v13, v167
  v_add_f32 v12, v12, v168
  v_add_f32 v13, v13, v169
  v_add_f32 v12, v12, v170
  v_add_f32 v13, v13, v171
  v_add_f32 v12, v12, v172
  v_mfma_f32_32x32x16_bf16 v[176:191], v[228:231], v[60:63], v[176:191]
  ds_read_b64_tr_b16 v[224:225], v7 offset:2048
  ds_read_b64_tr_b16 v[226:227], v7 offset:3072
  v_add_f32 v13, v13, v173
  v_add_f32 v12, v12, v174
  v_add_f32 v13, v13, v175
  v_cvt_pk_bf16_f32 v208, v160, v161
  v_cvt_pk_bf16_f32 v209, v162, v163
  v_cvt_pk_bf16_f32 v210, v164, v165
  v_cvt_pk_bf16_f32 v211, v166, v167
  v_cvt_pk_bf16_f32 v212, v168, v169
  v_cvt_pk_bf16_f32 v213, v170, v171
  v_cvt_pk_bf16_f32 v214, v172, v173
  v_cvt_pk_bf16_f32 v215, v174, v175
  s_mov_b32 s56, 1
  s_cmp_ge_u32 s24, 3
  s_cbranch_scc1 L_p1y_entry
L_p1:
  s_barrier
  s_setprio 1
  s_waitcnt lgkmcnt(8)
  v_mfma_f32_32x32x16_bf16 v[64:79], v[208:211], v[232:235], v[64:79]
  ds_read_b64_tr_b16 v[228:229], v8 offset:2048
  ds_read_b64_tr_b16 v[230:231], v8 offset:3072
  v_cvt_pk_bf16_f32 v176, 0, v176
  v_cvt_pk_bf16_f32 v177, 0, v177
  v_cvt_pk_bf16_f32 v178, 0, v178
  v_cvt_pk_bf16_f32 v179, 0, v179
  v_mfma_f32_32x32x16_bf16 v[80:95], v[208:211], v[236:239], v[80:95]
  ds_read_b64_tr_b16 v[232:233], v7 offset:6144
  ds_read_b64_tr_b16 v[234:235], v7 offset:7168
  v_cvt_pk_bf16_f32 v180, 0, v180
  v_cvt_pk_bf16_f32 v181, 0, v181
  v_cvt_pk_bf16_f32 v182, 0, v182
  v_cvt_pk_bf16_f32 v183, 0, v183
  v_mfma_f32_32x32x16_bf16 v[96:111], v[208:211], v[240:243], v[96:111]
  ds_read_b64_tr_b16 v[236:237], v8 offset:6144
  ds_read_b64_tr_b16 v[238:239], v8 offset:7168
  v_cvt_pk_bf16_f32 v184, 0, v184
  v_cvt_pk_bf16_f32 v185, 0, v185
  v_cvt_pk_bf16_f32 v186, 0, v186
  v_cvt_pk_bf16_f32 v187, 0, v187
  v_cvt_pk_bf16_f32 v188, 0, v188
  s_waitcnt lgkmcnt(8)
  v_mfma_f32_32x32x16_bf16 v[112:127], v[208:211], v[244:247], v[112:127]
  ds_read_b64_tr_b16 v[240:241], v7 offset:10240
  ds_read_b64_tr_b16 v[242:243], v7 offset:11264
  v_cvt_pk_bf16_f32 v189, 0, v189
  v_cvt_pk_bf16_f32 v190, 0, v190
  v_cvt_pk_bf16_f32 v191, 0, v191
  v_mfma_f32_32x32x16_bf16 v[128:143], v[208:211], v[216:219], v[128:143]
  ds_read_b64_tr_b16 v[244:245], v8 offset:10240
  ds_read_b64_tr_b16 v[246:247], v8 offset:11264
  v_add_f32 v176, v176, v192
  v_add_f32 v177, v177, v193
  v_add_f32 v178, v178, v194
  v_add_f32 v179, v179, v195
  v_add_f32 v180, v180, v196
  v_add_u32 v7, 12288, v7
  v_add_u32 v8, 12288, v8
  v_mfma_f32_32x32x16_bf16 v[144:159], v[208:211], v[220:223], v[144:159]
  ds_read_b128 v[216:219], v2 offset:0
  v_add_f32 v181, v181, v197
  v_add_f32 v182, v182, v198
  v_add_f32 v183, v183, v199
  v_add_f32 v184, v184, v200
  s_waitcnt lgkmcnt(7)
  v_mfma_f32_32x32x16_bf16 v[64:79], v[212:215], v[224:227], v[64:79]
  ds_read_b128 v[220:223], v3 offset:0
  v_add_f32 v185, v185, v201
  v_add_f32 v186, v186, v202
  v_add_f32 v187, v187, v203
  v_add_f32 v188, v188, v204
  v_mfma_f32_32x32x16_bf16 v[80:95], v[212:215], v[228:231], v[80:95]
  ds_read_b128 v[224:227], v4 offset:0
  s_setprio 0
  v_add_f32 v189, v189, v205
  v_add_f32 v190, v190, v206
  v_add_f32 v191, v191, v207
  v_cvt_pk_bf16_f32 v176, 0, v176
  v_cvt_pk_bf16_f32 v177, 0, v177
  v_mfma_f32_32x32x16_bf16 v[96:111], v[212:215], v[232:235], v[96:111]
  ds_read_b128 v[228:231], v5 offset:0
  v_cvt_pk_bf16_f32 v178, 0, v178
  v_cvt_pk_bf16_f32 v179, 0, v179
  v_cvt_pk_bf16_f32 v180, 0, v180
  v_fma_f32 v176, v176, v248, -4.0
  s_waitcnt lgkmcnt(4)
  v_mfma_f32_32x32x16_bf16 v[112:127], v[212:215], v[236:239], v[112:127]
  ds_read_b128 v[232:235], v2 offset:4096
  v_cvt_pk_bf16_f32 v181, 0, v181
  v_fma_f32 v177, v177, v248, -4.0
  v_cvt_pk_bf16_f32 v182, 0, v182
  v_fma_f32 v178, v178, v248, -4.0
  v_cvt_pk_bf16_f32 v183, 0, v183
  v_mfma_f32_32x32x16_bf16 v[128:143], v[212:215], v[240:243], v[128:143]
  ds_read_b128 v[236:239], v3 offset:4096
  v_fma_f32 v179, v179, v248, -4.0
  v_cvt_pk_bf16_f32 v184, 0, v184
  v_fma_f32 v180, v180, v248, -4.0
  v_cvt_pk_bf16_f32 v185, 0, v185
  v_mfma_f32_32x32x16_bf16 v[144:159], v[212:215], v[244:247], v[144:159]
  ds_read_b128 v[240:243], v4 offset:4096
  v_exp_f32 v176, v176
  v_fma_f32 v181, v181, v248, -4.0
  v_cvt_pk_bf16_f32 v186, 0, v186
  v_exp_f32 v177, v177
  s_waitcnt lgkmcnt(4)
  v_mfma_f32_32x32x16_bf16 v[160:175], v[216:219], v[16:19], 0
  ds_read_b128 v[244:247], v5 offset:4096
  v_fma_f32 v182, v182, v248, -4.0
  v_cvt_pk_bf16_f32 v187, 0, v187
  v_exp_f32 v178, v178
  v_fma_f32 v183, v183, v248, -4.0
  v_cvt_pk_bf16_f32 v188, 0, v188
  ds_read_b128 v[192:195], v6 offset:0
  ds_read_b128 v[196:199], v6 offset:32
  ds_read_b128 v[200:203], v6 offset:64
  ds_read_b128 v[204:207], v6 offset:96
  v_add_u32 v6, 128, v6
  v_mfma_f32_32x32x16_bf16 v[160:175], v[220:223], v[20:23], v[160:175]
  ds_read_b128 v[216:219], v2 offset:8192
  v_exp_f32 v179, v179
  v_fma_f32 v184, v184, v248, -4.0
  v_cvt_pk_bf16_f32 v189, 0, v189
  v_exp_f32 v180, v180
  v_mfma_f32_32x32x16_bf16 v[160:175], v[224:227], v[24:27], v[160:175]
  ds_read_b128 v[220:223], v3 offset:8192
  v_fma_f32 v185, v185, v248, -4.0
  v_cvt_pk_bf16_f32 v190, 0, v190
  v_exp_f32 v181, v181
  v_fma_f32 v186, v186, v248, -4.0
  v_cvt_pk_bf16_f32 v191, 0, v191
  s_waitcnt lgkmcnt(8)
  v_mfma_f32_32x32x16_bf16 v[160:175], v[228:231], v[28:31], v[160:175]
  ds_read_b128 v[224:227], v4 offset:8192
  v_exp_f32 v182, v182
  v_fma_f32 v187, v187, v248, -4.0
  v_exp_f32 v183, v183
  v_fma_f32 v188, v188, v248, -4.0
  v_mfma_f32_32x32x16_bf16 v[160:175], v[232:235], v[32:35], v[160:175]
  ds_read_b128 v[228:231], v5 offset:8192
  v_exp_f32 v184, v184
  v_fma_f32 v189, v189, v248, -4.0
  v_exp_f32 v185, v185
  v_fma_f32 v190, v190, v248, -4.0
  s_add_u32 s55, s55, 1
  s_cmp_eq_u32 s55, 3
  s_cselect_b32 s72, s83, s82
  s_cselect_b32 s55, 0, s55
  v_add_u32 v2, s72, v2
  v_add_u32 v3, s72, v3
  v_add_u32 v4, s72, v4
  v_add_u32 v5, s72, v5
  v_mfma_f32_32x32x16_bf16 v[160:175], v[236:239], v[36:39], v[160:175]
  ds_read_b64_tr_b16 v[232:233], v7 offset:0
  ds_read_b64_tr_b16 v[234:235], v7 offset:1024
  v_exp_f32 v186, v186
  v_fma_f32 v191, v191, v248, -4.0
  v_exp_f32 v187, v187
  v_exp_f32 v188, v188
  v_exp_f32 v189, v189
  s_waitcnt lgkmcnt(5)
  v_mfma_f32_32x32x16_bf16 v[160:175], v[240:243], v[40:43], v[160:175]
  ds_read_b64_tr_b16 v[236:237], v8 offset:0
  ds_read_b64_tr_b16 v[238:239], v8 offset:1024
  v_exp_f32 v190, v190
  v_exp_f32 v191, v191
  v_add_f32 v12, v12, v176
  v_add_f32 v13, v13, v177
  v_mfma_f32_32x32x16_bf16 v[160:175], v[244:247], v[44:47], v[160:175]
  ds_read_b64_tr_b16 v[240:241], v7 offset:4096
  ds_read_b64_tr_b16 v[242:243], v7 offset:5120
  v_add_f32 v12, v12, v178
  v_add_f32 v13, v13, v179
  v_add_f32 v12, v12, v180
  v_add_f32 v13, v13, v181
  v_add_f32 v12, v12, v182
  v_mfma_f32_32x32x16_bf16 v[160:175], v[216:219], v[48:51], v[160:175]
  ds_read_b64_tr_b16 v[244:245], v8 offset:4096
  ds_read_b64_tr_b16 v[246:247], v8 offset:5120
  v_add_f32 v13, v13, v183
  v_add_f32 v12, v12, v184
  v_add_f32 v13, v13, v185
  v_add_f32 v12, v12, v186
  s_waitcnt lgkmcnt(8)
  v_mfma_f32_32x32x16_bf16 v[160:175], v[220:223], v[52:55], v[160:175]
  ds_read_b64_tr_b16 v[216:217], v7 offset:8192
  ds_read_b64_tr_b16 v[218:219], v7 offset:9216
  v_add_f32 v13, v13, v187
  v_add_f32 v12, v12, v188
  v_add_f32 v13, v13, v189
  v_add_f32 v12, v12, v190
  v_add_f32 v13, v13, v191
  v_mfma_f32_32x32x16_bf16 v[160:175], v[224:227], v[56:59], v[160:175]
  ds_read_b64_tr_b16 v[220:221], v8 offset:8192
  ds_read_b64_tr_b16 v[222:223], v8 offset:9216
  v_cvt_pk_bf16_f32 v208, v176, v177
  v_cvt_pk_bf16_f32 v209, v178, v179
  v_cvt_pk_bf16_f32 v210, v180, v181
  v_cvt_pk_bf16_f32 v211, v182, v183
  v_mfma_f32_32x32x16_bf16 v[160:175], v[228:231], v[60:63], v[160:175]
  ds_read_b64_tr_b16 v[224:225], v7 offset:2048
  ds_read_b64_tr_b16 v[226:227], v7 offset:3072
  v_cvt_pk_bf16_f32 v212, v184, v185
  v_cvt_pk_bf16_f32 v213, v186, v187
  v_cvt_pk_bf16_f32 v214, v188, v189
  v_cvt_pk_bf16_f32 v215, v190, v191
  s_add_u32 s56, s56, 1
  s_barrier
  s_setprio 1
  s_waitcnt lgkmcnt(8)
  v_mfma_f32_32x32x16_bf16 v[64:79], v[208:211], v[232:235], v[64:79]
  ds_read_b64_tr_b16 v[228:229], v8 offset:2048
  ds_read_b64_tr_b16 v[230:231], v8 offset:3072
  v_cvt_pk_bf16_f32 v160, 0, v160
  v_cvt_pk_bf16_f32 v161, 0, v161
  v_cvt_pk_bf16_f32 v162, 0, v162
  v_cvt_pk_bf16_f32 v163, 0, v163
  v_mfma_f32_32x32x16_bf16 v[80:95], v[208:211], v[236:239], v[80:95]
  ds_read_b64_tr_b16 v[232:233], v7 offset:6144
  ds_read_b64_tr_b16 v[234:235], v7 offset:7168
  v_cvt_pk_bf16_f32 v164, 0, v164
  v_cvt_pk_bf16_f32 v165, 0, v165
  v_cvt_pk_bf16_f32 v166, 0, v166
  v_cvt_pk_bf16_f32 v167, 0, v167
  v_mfma_f32_32x32x16_bf16 v[96:111], v[208:211], v[240:243], v[96:111]
  ds_read_b64_tr_b16 v[236:237], v8 offset:6144
  ds_read_b64_tr_b16 v[238:239], v8 offset:7168
  v_cvt_pk_bf16_f32 v168, 0, v168
  v_cvt_pk_bf16_f32 v169, 0, v169
  v_cvt_pk_bf16_f32 v170, 0, v170
  v_cvt_pk_bf16_f32 v171, 0, v171
  v_cvt_pk_bf16_f32 v172, 0, v172
  s_waitcnt lgkmcnt(8)
  v_mfma_f32_32x32x16_bf16 v[112:127], v[208:211], v[244:247], v[112:127]
  ds_read_b64_tr_b16 v[240:241], v7 offset:10240
  ds_read_b64_tr_b16 v[242:243], v7 offset:11264
  v_cvt_pk_bf16_f32 v173, 0, v173
  v_cvt_pk_bf16_f32 v174, 0, v174
  v_cvt_pk_bf16_f32 v175, 0, v175
  v_mfma_f32_32x32x16_bf16 v[128:143], v[208:211], v[216:219], v[128:143]
  ds_read_b64_tr_b16 v[244:245], v8 offset:10240
  ds_read_b64_tr_b16 v[246:247], v8 offset:11264
  v_add_f32 v160, v160, v192
  v_add_f32 v161, v161, v193
  v_add_f32 v162, v162, v194
  v_add_f32 v163, v163, v195
  v_add_f32 v164, v164, v196
  v_add_u32 v7, 12288, v7
  v_add_u32 v8, 12288, v8
  v_mfma_f32_32x32x16_bf16 v[144:159], v[208:211], v[220:223], v[144:159]
  ds_read_b128 v[216:219], v2 offset:0
  v_add_f32 v165, v165, v197
  v_add_f32 v166, v166, v198
  v_add_f32 v167, v167, v199
  v_add_f32 v168, v168, v200
  s_waitcnt lgkmcnt(7)
  v_mfma_f32_32x32x16_bf16 v[64:79], v[212:215], v[224:227], v[64:79]
  ds_read_b128 v[220:223], v3 offset:0
  v_add_f32 v169, v169, v201
  v_add_f32 v170, v170, v202
  v_add_f32 v171, v171, v203
  v_add_f32 v172, v172, v204
  v_mfma_f32_32x32x16_bf16 v[80:95], v[212:215], v[228:231], v[80:95]
  ds_read_b128 v[224:227], v4 offset:0
  s_setprio 0
  v_add_f32 v173, v173, v205
  v_add_f32 v174, v174, v206
  v_add_f32 v175, v175, v207
  v_cvt_pk_bf16_f32 v160, 0, v160
  v_cvt_pk_bf16_f32 v161, 0, v161
  v_mfma_f32_32x32x16_bf16 v[96:111], v[212:215], v[232:235], v[96:111]
  ds_read_b128 v[228:231], v5 offset:0
  v_cvt_pk_bf16_f32 v162, 0, v162
  v_cvt_pk_bf16_f32 v163, 0, v163
  v_cvt_pk_bf16_f32 v164, 0, v164
  v_fma_f32 v160, v160, v248, -4.0
  s_waitcnt lgkmcnt(4)
  v_mfma_f32_32x32x16_bf16 v[112:127], v[212:215], v[236:239], v[112:127]
  ds_read_b128 v[232:235], v2 offset:4096
  v_cvt_pk_bf16_f32 v165, 0, v165
  v_fma_f32 v161, v161, v248, -4.0
  v_cvt_pk_bf16_f32 v166, 0, v166
  v_fma_f32 v162, v162, v248, -4.0
  v_cvt_pk_bf16_f32 v167, 0, v167
  v_mfma_f32_32x32x16_bf16 v[128:143], v[212:215], v[240:243], v[128:143]
  ds_read_b128 v[236:239], v3 offset:4096
  v_fma_f32 v163, v163, v248, -4.0
  v_cvt_pk_bf16_f32 v168, 0, v168
  v_fma_f32 v164, v164, v248, -4.0
  v_cvt_pk_bf16_f32 v169, 0, v169
  v_mfma_f32_32x32x16_bf16 v[144:159], v[212:215], v[244:247], v[144:159]
  ds_read_b128 v[240:243], v4 offset:4096
  v_exp_f32 v160, v160
  v_fma_f32 v165, v165, v248, -4.0
  v_cvt_pk_bf16_f32 v170, 0, v170
  v_exp_f32 v161, v161
  s_waitcnt lgkmcnt(4)
  v_mfma_f32_32x32x16_bf16 v[176:191], v[216:219], v[16:19], 0
  ds_read_b128 v[244:247], v5 offset:4096
  v_fma_f32 v166, v166, v248, -4.0
  v_cvt_pk_bf16_f32 v171, 0, v171
  v_exp_f32 v162, v162
  v_fma_f32 v167, v167, v248, -4.0
  v_cvt_pk_bf16_f32 v172, 0, v172
  ds_read_b128 v[192:195], v6 offset:0
  ds_read_b128 v[196:199], v6 offset:32
  ds_read_b128 v[200:203], v6 offset:64
  ds_read_b128 v[204:207], v6 offset:96
  v_add_u32 v6, 128, v6
  v_mfma_f32_32x32x16_bf16 v[176:191], v[220:223], v[20:23], v[176:191]
  ds_read_b128 v[216:219], v2 offset:8192
  v_exp_f32 v163, v163
  v_fma_f32 v168, v168, v248, -4.0
  v_cvt_pk_bf16_f32 v173, 0, v173
  v_exp_f32 v164, v164
  v_mfma_f32_32x32x16_bf16 v[176:191], v[224:227], v[24:27], v[176:191]
  ds_read_b128 v[220:223], v3 offset:8192
  v_fma_f32 v169, v169, v248, -4.0
  v_cvt_pk_bf16_f32 v174, 0, v174
  v_exp_f32 v165, v165
  v_fma_f32 v170, v170, v248, -4.0
  v_cvt_pk_bf16_f32 v175, 0, v175
  s_waitcnt lgkmcnt(8)
  v_mfma_f32_32x32x16_bf16 v[176:191], v[228:231], v[28:31], v[176:191]
  ds_read_b128 v[224:227], v4 offset:8192
  v_exp_f32 v166, v166
  v_fma_f32 v171, v171, v248, -4.0
  v_exp_f32 v167, v167
  v_fma_f32 v172, v172, v248, -4.0
  v_mfma_f32_32x32x16_bf16 v[176:191], v[232:235], v[32:35], v[176:191]
  ds_read_b128 v[228:231], v5 offset:8192
  v_exp_f32 v168, v168
  v_fma_f32 v173, v173, v248, -4.0
  v_exp_f32 v169, v169
  v_fma_f32 v174, v174, v248, -4.0
  s_add_u32 s55, s55, 1
  s_cmp_eq_u32 s55, 3
  s_cselect_b32 s72, s83, s82
  s_cselect_b32 s55, 0, s55
  v_add_u32 v2, s72, v2
  v_add_u32 v3, s72, v3
  v_add_u32 v4, s72, v4
  v_add_u32 v5, s72, v5
  v_mfma_f32_32x32x16_bf16 v[176:191], v[236:239], v[36:39], v[176:191]
  ds_read_b64_tr_b16 v[232:233], v7 offset:0
  ds_read_b64_tr_b16 v[234:235], v7 offset:1024
  v_exp_f32 v170, v170
  v_fma_f32 v175, v175, v248, -4.0
  v_exp_f32 v171, v171
  v_exp_f32 v172, v172
  v_exp_f32 v173, v173
  s_waitcnt lgkmcnt(5)
  v_mfma_f32_32x32x16_bf16 v[176:191], v[240:243], v[40:43], v[176:191]
  ds_read_b64_tr_b16 v[236:237], v8 offset:0
  ds_read_b64_tr_b16 v[238:239], v8 offset:1024
  v_exp_f32 v174, v174
  v_exp_f32 v175, v175
  v_add_f32 v12, v12, v160
  v_add_f32 v13, v13, v161
  v_mfma_f32_32x32x16_bf16 v[176:191], v[244:247], v[44:47], v[176:191]
  ds_read_b64_tr_b16 v[240:241], v7 offset:4096
  ds_read_b64_tr_b16 v[242:243], v7 offset:5120
  v_add_f32 v12, v12, v162
  v_add_f32 v13, v13, v163
  v_add_f32 v12, v12, v164
  v_add_f32 v13, v13, v165
  v_add_f32 v12, v12, v166
  v_mfma_f32_32x32x16_bf16 v[176:191], v[216:219], v[48:51], v[176:191]
  ds_read_b64_tr_b16 v[244:245], v8 offset:4096
  ds_read_b64_tr_b16 v[246:247], v8 offset:5120
  v_add_f32 v13, v13, v167
  v_add_f32 v12, v12, v168
  v_add_f32 v13, v13, v169
  v_add_f32 v12, v12, v170
  s_waitcnt lgkmcnt(8)
  v_mfma_f32_32x32x16_bf16 v[176:191], v[220:223], v[52:55], v[176:191]
  ds_read_b64_tr_b16 v[216:217], v7 offset:8192
  ds_read_b64_tr_b16 v[218:219], v7 offset:9216
  v_add_f32 v13, v13, v171
  v_add_f32 v12, v12, v172
  v_add_f32 v13, v13, v173
  v_add_f32 v12, v12, v174
  v_add_f32 v13, v13, v175
  v_mfma_f32_32x32x16_bf16 v[176:191], v[224:227], v[56:59], v[176:191]
  ds_read_b64_tr_b16 v[220:221], v8 offset:8192
  ds_read_b64_tr_b16 v[222:223], v8 offset:9216
  v_cvt_pk_bf16_f32 v208, v160, v161
  v_cvt_pk_bf16_f32 v209, v162, v163
  v_cvt_pk_bf16_f32 v210, v164, v165
  v_cvt_pk_bf16_f32 v211, v166, v167
  v_mfma_f32_32x32x16_bf16 v[176:191], v[228:231], v[60:63], v[176:191]
  ds_read_b64_tr_b16 v[224:225], v7 offset:2048
  ds_read_b64_tr_b16 v[226:227], v7 offset:3072
  v_cvt_pk_bf16_f32 v212, v168, v169
  v_cvt_pk_bf16_f32 v213, v170, v171
  v_cvt_pk_bf16_f32 v214, v172, v173
  v_cvt_pk_bf16_f32 v215, v174, v175
  s_add_u32 s56, s56, 1
  s_cmp_lt_u32 s56, 7
  s_cbranch_scc1 L_p1
  s_branch L_p1_done
L_p1y_entry:
L_p1y:
  s_barrier
  s_setprio 0
  s_waitcnt lgkmcnt(8)
  v_mfma_f32_32x32x16_bf16 v[64:79], v[208:211], v[232:235], v[64:79]
  ds_read_b64_tr_b16 v[228:229], v8 offset:2048
  ds_read_b64_tr_b16 v[230:231], v8 offset:3072
  v_cvt_pk_bf16_f32 v176, 0, v176
  v_cvt_pk_bf16_f32 v177, 0, v177
  v_cvt_pk_bf16_f32 v178, 0, v178
  v_cvt_pk_bf16_f32 v179, 0, v179
  v_mfma_f32_32x32x16_bf16 v[80:95], v[208:211], v[236:239], v[80:95]
  ds_read_b64_tr_b16 v[232:233], v7 offset:6144
  ds_read_b64_tr_b16 v[234:235], v7 offset:7168
  v_cvt_pk_bf16_f32 v180, 0, v180
  v_cvt_pk_bf16_f32 v181, 0, v181
  v_cvt_pk_bf16_f32 v182, 0, v182
  v_cvt_pk_bf16_f32 v183, 0, v183
  v_mfma_f32_32x32x16_bf16 v[96:111], v[208:211], v[240:243], v[96:111]
  ds_read_b64_tr_b16 v[236:237], v8 offset:6144
  ds_read_b64_tr_b16 v[238:239], v8 offset:7168
  v_cvt_pk_bf16_f32 v184, 0, v184
  v_cvt_pk_bf16_f32 v185, 0, v185
  v_cvt_pk_bf16_f32 v186, 0, v186
  v_cvt_pk_bf16_f32 v187, 0, v187
  v_cvt_pk_bf16_f32 v188, 0, v188
  s_waitcnt lgkmcnt(8)
  v_mfma_f32_32x32x16_bf16 v[112:127], v[208:211], v[244:247], v[112:127]
  ds_read_b64_tr_b16 v[240:241], v7 offset:10240
  ds_read_b64_tr_b16 v[242:243], v7 offset:11264
  v_cvt_pk_bf16_f32 v189, 0, v189
  v_cvt_pk_bf16_f32 v190, 0, v190
  v_cvt_pk_bf16_f32 v191, 0, v191
  v_mfma_f32_32x32x16_bf16 v[128:143], v[208:211], v[216:219], v[128:143]
  ds_read_b64_tr_b16 v[244:245], v8 offset:10240
  ds_read_b64_tr_b16 v[246:247], v8 offset:11264
  v_add_f32 v176, v176, v192
  v_add_f32 v177, v177, v193
  v_add_f32 v178, v178, v194
  v_add_f32 v179, v179, v195
  v_add_f32 v180, v180, v196
  v_add_u32 v7, 12288, v7
  v_add_u32 v8, 12288, v8
  v_mfma_f32_32x32x16_bf16 v[144:159], v[208:211], v[220:223], v[144:159]
  ds_read_b128 v[216:219], v2 offset:0
  v_add_f32 v181, v181, v197
  v_add_f32 v182, v182, v198
  v_add_f32 v183, v183, v199
  v_add_f32 v184, v184, v200
  s_waitcnt lgkmcnt(7)
  v_mfma_f32_32x32x16_bf16 v[64:79], v[212:215], v[224:227], v[64:79]
  ds_read_b128 v[220:223], v3 offset:0
  v_add_f32 v185, v185, v201
  v_add_f32 v186, v186, v202
  v_add_f32 v187, v187, v203
  v_add_f32 v188, v188, v204
  v_mfma_f32_32x32x16_bf16 v[80:95], v[212:215], v[228:231], v[80:95]
  ds_read_b128 v[224:227], v4 offset:0
  s_setprio 1
  v_add_f32 v189, v189, v205
  v_add_f32 v190, v190, v206
  v_add_f32 v191, v191, v207
  v_cvt_pk_bf16_f32 v176, 0, v176
  v_cvt_pk_bf16_f32 v177, 0, v177
  v_mfma_f32_32x32x16_bf16 v[96:111], v[212:215], v[232:235], v[96:111]
  ds_read_b128 v[228:231], v5 offset:0
  v_cvt_pk_bf16_f32 v178, 0, v178
  v_cvt_pk_bf16_f32 v179, 0, v179
  v_cvt_pk_bf16_f32 v180, 0, v180
  v_fma_f32 v176, v176, v248, -4.0
  s_waitcnt lgkmcnt(4)
  v_mfma_f32_32x32x16_bf16 v[112:127], v[212:215], v[236:239], v[112:127]
  ds_read_b128 v[232:235], v2 offset:4096
  v_cvt_pk_bf16_f32 v181, 0, v181
  v_fma_f32 v177, v177, v248, -4.0
  v_cvt_pk_bf16_f32 v182, 0, v182
  v_fma_f32 v178, v178, v248, -4.0
  v_cvt_pk_bf16_f32 v183, 0, v183
  v_mfma_f32_32x32x16_bf16 v[128:143], v[212:215], v[240:243], v[128:143]
  ds_read_b128 v[236:239], v3 offset:4096
  v_fma_f32 v179, v179, v248, -4.0
  v_cvt_pk_bf16_f32 v184, 0, v184
  v_fma_f32 v180, v180, v248, -4.0
  v_cvt_pk_bf16_f32 v185, 0, v185
  v_mfma_f32_32x32x16_bf16 v[144:159], v[212:215], v[244:247], v[144:159]
  ds_read_b128 v[240:243], v4 offset:4096
  v_exp_f32 v176, v176
  v_fma_f32 v181, v181, v248, -4.0
  v_cvt_pk_bf16_f32 v186, 0, v186
  v_exp_f32 v177, v177
  s_waitcnt lgkmcnt(4)
  v_mfma_f32_32x32x16_bf16 v[160:175], v[216:219], v[16:19], 0
  ds_read_b128 v[244:247], v5 offset:4096
  v_fma_f32 v182, v182, v248, -4.0
  v_cvt_pk_bf16_f32 v187, 0, v187
  v_exp_f32 v178, v178
  v_fma_f32 v183, v183, v248, -4.0
  v_cvt_pk_bf16_f32 v188, 0, v188
  ds_read_b128 v[192:195], v6 offset:0
  ds_read_b128 v[196:199], v6 offset:32
  ds_read_b128 v[200:203], v6 offset:64
  ds_read_b128 v[204:207], v6 offset:96
  v_add_u32 v6, 128, v6
  v_mfma_f32_32x32x16_bf16 v[160:175], v[220:223], v[20:23], v[160:175]
  ds_read_b128 v[216:219], v2 offset:8192
  v_exp_f32 v179, v179
  v_fma_f32 v184, v184, v248, -4.0
  v_cvt_pk_bf16_f32 v189, 0, v189
  v_exp_f32 v180, v180
  v_mfma_f32_32x32x16_bf16 v[160:175], v[224:227], v[24:27], v[160:175]
  ds_read_b128 v[220:223], v3 offset:8192
  v_fma_f32 v185, v185, v248, -4.0
  v_cvt_pk_bf16_f32 v190, 0, v190
  v_exp_f32 v181, v181
  v_fma_f32 v186, v186, v248, -4.0
  v_cvt_pk_bf16_f32 v191, 0, v191
  s_waitcnt lgkmcnt(8)
  v_mfma_f32_32x32x16_bf16 v[160:175], v[228:231], v[28:31], v[160:175]
  ds_read_b128 v[224:227], v4 offset:8192
  v_exp_f32 v182, v182
  v_fma_f32 v187, v187, v248, -4.0
  v_exp_f32 v183, v183
  v_fma_f32 v188, v188, v248, -4.0
  v_mfma_f32_32x32x16_bf16 v[160:175], v[232:235], v[32:35], v[160:175]
  ds_read_b128 v[228:231], v5 offset:8192
  v_exp_f32 v184, v184
  v_fma_f32 v189, v189, v248, -4.0
  v_exp_f32 v185, v185
  v_fma_f32 v190, v190, v248, -4.0
  s_add_u32 s55, s55, 1
  s_cmp_eq_u32 s55, 3
  s_cselect_b32 s72, s83, s82
  s_cselect_b32 s55, 0, s55
  v_add_u32 v2, s72, v2
  v_add_u32 v3, s72, v3
  v_add_u32 v4, s72, v4
  v_add_u32 v5, s72, v5
  v_mfma_f32_32x32x16_bf16 v[160:175], v[236:239], v[36:39], v[160:175]
  ds_read_b64_tr_b16 v[232:233], v7 offset:0
  ds_read_b64_tr_b16 v[234:235], v7 offset:1024
  v_exp_f32 v186, v186
  v_fma_f32 v191, v191, v248, -4.0
  v_exp_f32 v187, v187
  v_exp_f32 v188, v188
  v_exp_f32 v189, v189
  s_waitcnt lgkmcnt(5)
  v_mfma_f32_32x32x16_bf16 v[160:175], v[240:243], v[40:43], v[160:175]
  ds_read_b64_tr_b16 v[236:237], v8 offset:0
  ds_read_b64_tr_b16 v[238:239], v8 offset:1024
  v_exp_f32 v190, v190
  v_exp_f32 v191, v191
  v_add_f32 v12, v12, v176
  v_add_f32 v13, v13, v177
  v_mfma_f32_32x32x16_bf16 v[160:175], v[244:247], v[44:47], v[160:175]
  ds_read_b64_tr_b16 v[240:241], v7 offset:4096
  ds_read_b64_tr_b16 v[242:243], v7 offset:5120
  v_add_f32 v12, v12, v178
  v_add_f32 v13, v13, v179
  v_add_f32 v12, v12, v180
  v_add_f32 v13, v13, v181
  v_add_f32 v12, v12, v182
  v_mfma_f32_32x32x16_bf16 v[160:175], v[216:219], v[48:51], v[160:175]
  ds_read_b64_tr_b16 v[244:245], v8 offset:4096
  ds_read_b64_tr_b16 v[246:247], v8 offset:5120
  v_add_f32 v13, v13, v183
  v_add_f32 v12, v12, v184
  v_add_f32 v13, v13, v185
  v_add_f32 v12, v12, v186
  s_waitcnt lgkmcnt(8)
  v_mfma_f32_32x32x16_bf16 v[160:175], v[220:223], v[52:55], v[160:175]
  ds_read_b64_tr_b16 v[216:217], v7 offset:8192
  ds_read_b64_tr_b16 v[218:219], v7 offset:9216
  v_add_f32 v13, v13, v187
  v_add_f32 v12, v12, v188
  v_add_f32 v13, v13, v189
  v_add_f32 v12, v12, v190
  v_add_f32 v13, v13, v191
  v_mfma_f32_32x32x16_bf16 v[160:175], v[224:227], v[56:59], v[160:175]
  ds_read_b64_tr_b16 v[220:221], v8 offset:8192
  ds_read_b64_tr_b16 v[222:223], v8 offset:9216
  v_cvt_pk_bf16_f32 v208, v176, v177
  v_cvt_pk_bf16_f32 v209, v178, v179
  v_cvt_pk_bf16_f32 v210, v180, v181
  v_cvt_pk_bf16_f32 v211, v182, v183
  v_mfma_f32_32x32x16_bf16 v[160:175], v[228:231], v[60:63], v[160:175]
  ds_read_b64_tr_b16 v[224:225], v7 offset:2048
  ds_read_b64_tr_b16 v[226:227], v7 offset:3072
  v_cvt_pk_bf16_f32 v212, v184, v185
  v_cvt_pk_bf16_f32 v213, v186, v187
  v_cvt_pk_bf16_f32 v214, v188, v189
  v_cvt_pk_bf16_f32 v215, v190, v191
  s_add_u32 s56, s56, 1
  s_barrier
  s_setprio 0
  s_waitcnt lgkmcnt(8)
  v_mfma_f32_32x32x16_bf16 v[64:79], v[208:211], v[232:235], v[64:79]
  ds_read_b64_tr_b16 v[228:229], v8 offset:2048
  ds_read_b64_tr_b16 v[230:231], v8 offset:3072
  v_cvt_pk_bf16_f32 v160, 0, v160
  v_cvt_pk_bf16_f32 v161, 0, v161
  v_cvt_pk_bf16_f32 v162, 0, v162
  v_cvt_pk_bf16_f32 v163, 0, v163
  v_mfma_f32_32x32x16_bf16 v[80:95], v[208:211], v[236:239], v[80:95]
  ds_read_b64_tr_b16 v[232:233], v7 offset:6144
  ds_read_b64_tr_b16 v[234:235], v7 offset:7168
  v_cvt_pk_bf16_f32 v164, 0, v164
  v_cvt_pk_bf16_f32 v165, 0, v165
  v_cvt_pk_bf16_f32 v166, 0, v166
  v_cvt_pk_bf16_f32 v167, 0, v167
  v_mfma_f32_32x32x16_bf16 v[96:111], v[208:211], v[240:243], v[96:111]
  ds_read_b64_tr_b16 v[236:237], v8 offset:6144
  ds_read_b64_tr_b16 v[238:239], v8 offset:7168
  v_cvt_pk_bf16_f32 v168, 0, v168
  v_cvt_pk_bf16_f32 v169, 0, v169
  v_cvt_pk_bf16_f32 v170, 0, v170
  v_cvt_pk_bf16_f32 v171, 0, v171
  v_cvt_pk_bf16_f32 v172, 0, v172
  s_waitcnt lgkmcnt(8)
  v_mfma_f32_32x32x16_bf16 v[112:127], v[208:211], v[244:247], v[112:127]
  ds_read_b64_tr_b16 v[240:241], v7 offset:10240
  ds_read_b64_tr_b16 v[242:243], v7 offset:11264
  v_cvt_pk_bf16_f32 v173, 0, v173
  v_cvt_pk_bf16_f32 v174, 0, v174
  v_cvt_pk_bf16_f32 v175, 0, v175
  v_mfma_f32_32x32x16_bf16 v[128:143], v[208:211], v[216:219], v[128:143]
  ds_read_b64_tr_b16 v[244:245], v8 offset:10240
  ds_read_b64_tr_b16 v[246:247], v8 offset:11264
  v_add_f32 v160, v160, v192
  v_add_f32 v161, v161, v193
  v_add_f32 v162, v162, v194
  v_add_f32 v163, v163, v195
  v_add_f32 v164, v164, v196
  v_add_u32 v7, 12288, v7
  v_add_u32 v8, 12288, v8
  v_mfma_f32_32x32x16_bf16 v[144:159], v[208:211], v[220:223], v[144:159]
  ds_read_b128 v[216:219], v2 offset:0
  v_add_f32 v165, v165, v197
  v_add_f32 v166, v166, v198
  v_add_f32 v167, v167, v199
  v_add_f32 v168, v168, v200
  s_waitcnt lgkmcnt(7)
  v_mfma_f32_32x32x16_bf16 v[64:79], v[212:215], v[224:227], v[64:79]
  ds_read_b128 v[220:223], v3 offset:0
  v_add_f32 v169, v169, v201
  v_add_f32 v170, v170, v202
  v_add_f32 v171, v171, v203
  v_add_f32 v172, v172, v204
  v_mfma_f32_32x32x16_bf16 v[80:95], v[212:215], v[228:231], v[80:95]
  ds_read_b128 v[224:227], v4 offset:0
  s_setprio 1
  v_add_f32 v173, v173, v205
  v_add_f32 v174, v174, v206
  v_add_f32 v175, v175, v207
  v_cvt_pk_bf16_f32 v160, 0, v160
  v_cvt_pk_bf16_f32 v161, 0, v161
  v_mfma_f32_32x32x16_bf16 v[96:111], v[212:215], v[232:235], v[96:111]
  ds_read_b128 v[228:231], v5 offset:0
  v_cvt_pk_bf16_f32 v162, 0, v162
  v_cvt_pk_bf16_f32 v163, 0, v163
  v_cvt_pk_bf16_f32 v164, 0, v164
  v_fma_f32 v160, v160, v248, -4.0
  s_waitcnt lgkmcnt(4)
  v_mfma_f32_32x32x16_bf16 v[112:127], v[212:215], v[236:239], v[112:127]
  ds_read_b128 v[232:235], v2 offset:4096
  v_cvt_pk_bf16_f32 v165, 0, v165
  v_fma_f32 v161, v161, v248, -4.0
  v_cvt_pk_bf16_f32 v166, 0, v166
  v_fma_f32 v162, v162, v248, -4.0
  v_cvt_pk_bf16_f32 v167, 0, v167
  v_mfma_f32_32x32x16_bf16 v[128:143], v[212:215], v[240:243], v[128:143]
  ds_read_b128 v[236:239], v3 offset:4096
  v_fma_f32 v163, v163, v248, -4.0
  v_cvt_pk_bf16_f32 v168, 0, v168
  v_fma_f32 v164, v164, v248, -4.0
  v_cvt_pk_bf16_f32 v169, 0, v169
  v_mfma_f32_32x32x16_bf16 v[144:159], v[212:215], v[244:247], v[144:159]
  ds_read_b128 v[240:243], v4 offset:4096
  v_exp_f32 v160, v160
  v_fma_f32 v165, v165, v248, -4.0
  v_cvt_pk_bf16_f32 v170, 0, v170
  v_exp_f32 v161, v161
  s_waitcnt lgkmcnt(4)
  v_mfma_f32_32x32x16_bf16 v[176:191], v[216:219], v[16:19], 0
  ds_read_b128 v[244:247], v5 offset:4096
  v_fma_f32 v166, v166, v248, -4.0
  v_cvt_pk_bf16_f32 v171, 0, v171
  v_exp_f32 v162, v162
  v_fma_f32 v167, v167, v248, -4.0
  v_cvt_pk_bf16_f32 v172, 0, v172
  ds_read_b128 v[192:195], v6 offset:0
  ds_read_b128 v[196:199], v6 offset:32
  ds_read_b128 v[200:203], v6 offset:64
  ds_read_b128 v[204:207], v6 offset:96
  v_add_u32 v6, 128, v6
  v_mfma_f32_32x32x16_bf16 v[176:191], v[220:223], v[20:23], v[176:191]
  ds_read_b128 v[216:219], v2 offset:8192
  v_exp_f32 v163, v163
  v_fma_f32 v168, v168, v248, -4.0
  v_cvt_pk_bf16_f32 v173, 0, v173
  v_exp_f32 v164, v164
  v_mfma_f32_32x32x16_bf16 v[176:191], v[224:227], v[24:27], v[176:191]
  ds_read_b128 v[220:223], v3 offset:8192
  v_fma_f32 v169, v169, v248, -4.0
  v_cvt_pk_bf16_f32 v174, 0, v174
  v_exp_f32 v165, v165
  v_fma_f32 v170, v170, v248, -4.0
  v_cvt_pk_bf16_f32 v175, 0, v175
  s_waitcnt lgkmcnt(8)
  v_mfma_f32_32x32x16_bf16 v[176:191], v[228:231], v[28:31], v[176:191]
  ds_read_b128 v[224:227], v4 offset:8192
  v_exp_f32 v166, v166
  v_fma_f32 v171, v171, v248, -4.0
  v_exp_f32 v167, v167
  v_fma_f32 v172, v172, v248, -4.0
  v_mfma_f32_32x32x16_bf16 v[176:191], v[232:235], v[32:35], v[176:191]
  ds_read_b128 v[228:231], v5 offset:8192
  v_exp_f32 v168, v168
  v_fma_f32 v173, v173, v248, -4.0
  v_exp_f32 v169, v169
  v_fma_f32 v174, v174, v248, -4.0
  s_add_u32 s55, s55, 1
  s_cmp_eq_u32 s55, 3
  s_cselect_b32 s72, s83, s82
  s_cselect_b32 s55, 0, s55
  v_add_u32 v2, s72, v2
  v_add_u32 v3, s72, v3
  v_add_u32 v4, s72, v4
  v_add_u32 v5, s72, v5
  v_mfma_f32_32x32x16_bf16 v[176:191], v[236:239], v[36:39], v[176:191]
  ds_read_b64_tr_b16 v[232:233], v7 offset:0
  ds_read_b64_tr_b16 v[234:235], v7 offset:1024
  v_exp_f32 v170, v170
  v_fma_f32 v175, v175, v248, -4.0
  v_exp_f32 v171, v171
  v_exp_f32 v172, v172
  v_exp_f32 v173, v173
  s_waitcnt lgkmcnt(5)
  v_mfma_f32_32x32x16_bf16 v[176:191], v[240:243], v[40:43], v[176:191]
  ds_read_b64_tr_b16 v[236:237], v8 offset:0
  ds_read_b64_tr_b16 v[238:239], v8 offset:1024
  v_exp_f32 v174, v174
  v_exp_f32 v175, v175
  v_add_f32 v12, v12, v160
  v_add_f32 v13, v13, v161
  v_mfma_f32_32x32x16_bf16 v[176:191], v[244:247], v[44:47], v[176:191]
  ds_read_b64_tr_b16 v[240:241], v7 offset:4096
  ds_read_b64_tr_b16 v[242:243], v7 offset:5120
  v_add_f32 v12, v12, v162
  v_add_f32 v13, v13, v163
  v_add_f32 v12, v12, v164
  v_add_f32 v13, v13, v165
  v_add_f32 v12, v12, v166
  v_mfma_f32_32x32x16_bf16 v[176:191], v[216:219], v[48:51], v[176:191]
  ds_read_b64_tr_b16 v[244:245], v8 offset:4096
  ds_read_b64_tr_b16 v[246:247], v8 offset:5120
  v_add_f32 v13, v13, v167
  v_add_f32 v12, v12, v168
  v_add_f32 v13, v13, v169
  v_add_f32 v12, v12, v170
  s_waitcnt lgkmcnt(8)
  v_mfma_f32_32x32x16_bf16 v[176:191], v[220:223], v[52:55], v[176:191]
  ds_read_b64_tr_b16 v[216:217], v7 offset:8192
  ds_read_b64_tr_b16 v[218:219], v7 offset:9216
  v_add_f32 v13, v13, v171
  v_add_f32 v12, v12, v172
  v_add_f32 v13, v13, v173
  v_add_f32 v12, v12, v174
  v_add_f32 v13, v13, v175
  v_mfma_f32_32x32x16_bf16 v[176:191], v[224:227], v[56:59], v[176:191]
  ds_read_b64_tr_b16 v[220:221], v8 offset:8192
  ds_read_b64_tr_b16 v[222:223], v8 offset:9216
  v_cvt_pk_bf16_f32 v208, v160, v161
  v_cvt_pk_bf16_f32 v209, v162, v163
  v_cvt_pk_bf16_f32 v210, v164, v165
  v_cvt_pk_bf16_f32 v211, v166, v167
  v_mfma_f32_32x32x16_bf16 v[176:191], v[228:231], v[60:63], v[176:191]
  ds_read_b64_tr_b16 v[224:225], v7 offset:2048
  ds_read_b64_tr_b16 v[226:227], v7 offset:3072
  v_cvt_pk_bf16_f32 v212, v168, v169
  v_cvt_pk_bf16_f32 v213, v170, v171
  v_cvt_pk_bf16_f32 v214, v172, v173
  v_cvt_pk_bf16_f32 v215, v174, v175
  s_add_u32 s56, s56, 1
  s_cmp_lt_u32 s56, 7
  s_cbranch_scc1 L_p1y
L_p1_done:
  s_setprio 0
  s_barrier
  s_waitcnt lgkmcnt(8)
  v_mfma_f32_32x32x16_bf16 v[64:79], v[208:211], v[232:235], v[64:79]
  ds_read_b64_tr_b16 v[228:229], v8 offset:2048
  ds_read_b64_tr_b16 v[230:231], v8 offset:3072
  v_cvt_pk_bf16_f32 v176, 0, v176
  v_cvt_pk_bf16_f32 v177, 0, v177
  v_cvt_pk_bf16_f32 v178, 0, v178
  v_cvt_pk_bf16_f32 v179, 0, v179
  v_cvt_pk_bf16_f32 v180, 0, v180
  v_cvt_pk_bf16_f32 v181, 0, v181
  v_cvt_pk_bf16_f32 v182, 0, v182
  v_cvt_pk_bf16_f32 v183, 0, v183
  v_mfma_f32_32x32x16_bf16 v[80:95], v[208:211], v[236:239], v[80:95]
  ds_read_b64_tr_b16 v[232:233], v7 offset:6144
  ds_read_b64_tr_b16 v[234:235], v7 offset:7168
  v_cvt_pk_bf16_f32 v184, 0, v184
  v_cvt_pk_bf16_f32 v185, 0, v185
  v_cvt_pk_bf16_f32 v186, 0, v186
  v_cvt_pk_bf16_f32 v187, 0, v187
  v_cvt_pk_bf16_f32 v188, 0, v188
  v_cvt_pk_bf16_f32 v189, 0, v189
  v_cvt_pk_bf16_f32 v190, 0, v190
  v_cvt_pk_bf16_f32 v191, 0, v191
  v_mfma_f32_32x32x16_bf16 v[96:111], v[208:211], v[240:243], v[96:111]
  ds_read_b64_tr_b16 v[236:237], v8 offset:6144
  ds_read_b64_tr_b16 v[238:239], v8 offset:7168
  v_add_f32 v176, v176, v192
  v_add_f32 v177, v177, v193
  v_add_f32 v178, v178, v194
  v_add_f32 v179, v179, v195
  v_add_f32 v180, v180, v196
  v_add_f32 v181, v181, v197
  v_add_f32 v182, v182, v198
  s_waitcnt lgkmcnt(8)
  v_mfma_f32_32x32x16_bf16 v[112:127], v[208:211], v[244:247], v[112:127]
  ds_read_b64_tr_b16 v[240:241], v7 offset:10240
  ds_read_b64_tr_b16 v[242:243], v7 offset:11264
  v_add_f32 v183, v183, v199
  v_add_f32 v184, v184, v200
  v_add_f32 v185, v185, v201
  v_add_f32 v186, v186, v202
  v_add_f32 v187, v187, v203
  v_add_f32 v188, v188, v204
  v_add_f32 v189, v189, v205
  v_add_f32 v190, v190, v206
  v_mfma_f32_32x32x16_bf16 v[128:143], v[208:211], v[216:219], v[128:143]
  ds_read_b64_tr_b16 v[244:245], v8 offset:10240
  ds_read_b64_tr_b16 v[246:247], v8 offset:11264
  v_add_f32 v191, v191, v207
  v_cvt_pk_bf16_f32 v176, 0, v176
  v_cvt_pk_bf16_f32 v177, 0, v177
  v_cvt_pk_bf16_f32 v178, 0, v178
  v_cvt_pk_bf16_f32 v179, 0, v179
  v_cvt_pk_bf16_f32 v180, 0, v180
  v_cvt_pk_bf16_f32 v181, 0, v181
  v_cvt_pk_bf16_f32 v182, 0, v182
  v_add_u32 v7, 12288, v7
  v_add_u32 v8, 12288, v8
  v_mfma_f32_32x32x16_bf16 v[144:159], v[208:211], v[220:223], v[144:159]
  ds_read_b64_tr_b16 v[216:217], v7 offset:0
  ds_read_b64_tr_b16 v[218:219], v7 offset:1024
  v_cvt_pk_bf16_f32 v183, 0, v183
  v_cvt_pk_bf16_f32 v184, 0, v184
  v_cvt_pk_bf16_f32 v185, 0, v185
  v_cvt_pk_bf16_f32 v186, 0, v186
  v_cvt_pk_bf16_f32 v187, 0, v187
  v_cvt_pk_bf16_f32 v188, 0, v188
  v_cvt_pk_bf16_f32 v189, 0, v189
  v_cvt_pk_bf16_f32 v190, 0, v190
  s_waitcnt lgkmcnt(8)
  v_mfma_f32_32x32x16_bf16 v[64:79], v[212:215], v[224:227], v[64:79]
  ds_read_b64_tr_b16 v[220:221], v8 offset:0
  ds_read_b64_tr_b16 v[222:223], v8 offset:1024
  v_cvt_pk_bf16_f32 v191, 0, v191
  v_fma_f32 v176, v176, v248, -4.0
  v_fma_f32 v177, v177, v248, -4.0
  v_fma_f32 v178, v178, v248, -4.0
  v_fma_f32 v179, v179, v248, -4.0
  v_fma_f32 v180, v180, v248, -4.0
  v_fma_f32 v181, v181, v248, -4.0
  v_fma_f32 v182, v182, v248, -4.0
  v_mfma_f32_32x32x16_bf16 v[80:95], v[212:215], v[228:231], v[80:95]
  ds_read_b64_tr_b16 v[224:225], v7 offset:4096
  ds_read_b64_tr_b16 v[226:227], v7 offset:5120
  v_fma_f32 v183, v183, v248, -4.0
  v_fma_f32 v184, v184, v248, -4.0
  v_fma_f32 v185, v185, v248, -4.0
  v_fma_f32 v186, v186, v248, -4.0
  v_fma_f32 v187, v187, v248, -4.0
  v_fma_f32 v188, v188, v248, -4.0
  v_fma_f32 v189, v189, v248, -4.0
  v_fma_f32 v190, v190, v248, -4.0
  v_mfma_f32_32x32x16_bf16 v[96:111], v[212:215], v[232:235], v[96:111]
  ds_read_b64_tr_b16 v[228:229], v8 offset:4096
  ds_read_b64_tr_b16 v[230:231], v8 offset:5120
  v_fma_f32 v191, v191, v248, -4.0
  v_exp_f32 v176, v176
  v_exp_f32 v177, v177
  v_exp_f32 v178, v178
  v_exp_f32 v179, v179
  v_exp_f32 v180, v180
  v_exp_f32 v181, v181
  v_exp_f32 v182, v182
  s_waitcnt lgkmcnt(8)
  v_mfma_f32_32x32x16_bf16 v[112:127], v[212:215], v[236:239], v[112:127]
  ds_read_b64_tr_b16 v[232:233], v7 offset:8192
  ds_read_b64_tr_b16 v[234:235], v7 offset:9216
  v_exp_f32 v183, v183
  v_exp_f32 v184, v184
  v_exp_f32 v185, v185
  v_exp_f32 v186, v186
  v_exp_f32 v187, v187
  v_exp_f32 v188, v188
  v_exp_f32 v189, v189
  v_exp_f32 v190, v190
  v_mfma_f32_32x32x16_bf16 v[128:143], v[212:215], v[240:243], v[128:143]
  ds_read_b64_tr_b16 v[236:237], v8 offset:8192
  ds_read_b64_tr_b16 v[238:239], v8 offset:9216
  v_exp_f32 v191, v191
  v_add_f32 v12, v12, v176
  v_add_f32 v13, v13, v177
  v_add_f32 v12, v12, v178
  v_add_f32 v13, v13, v179
  v_add_f32 v12, v12, v180
  v_add_f32 v13, v13, v181
  v_add_f32 v12, v12, v182
  v_mfma_f32_32x32x16_bf16 v[144:159], v[212:215], v[244:247], v[144:159]
  ds_read_b64_tr_b16 v[240:241], v7 offset:2048
  ds_read_b64_tr_b16 v[242:243], v7 offset:3072
  v_add_f32 v13, v13, v183
  v_add_f32 v12, v12, v184
  v_add_f32 v13, v13, v185
  v_add_f32 v12, v12, v186
  v_add_f32 v13, v13, v187
  v_add_f32 v12, v12, v188
  v_add_f32 v13, v13, v189
  v_add_f32 v12, v12, v190
  v_add_f32 v13, v13, v191
  v_cvt_pk_bf16_f32 v208, v176, v177
  v_cvt_pk_bf16_f32 v209, v178, v179
  v_cvt_pk_bf16_f32 v210, v180, v181
  v_cvt_pk_bf16_f32 v211, v182, v183
  v_cvt_pk_bf16_f32 v212, v184, v185
  v_cvt_pk_bf16_f32 v213, v186, v187
  v_cvt_pk_bf16_f32 v214, v188, v189
  v_cvt_pk_bf16_f32 v215, v190, v191
  v_mov_b32 v250, 137728
  ds_read_b64 v[250:251], v250 offset:8
  s_add_u32 s40, s16, s25
  s_addc_u32 s41, s17, 0
  s_and_b32 s41, s41, 0xffff
  s_mov_b32 s42, 98304
  s_mov_b32 s43, 0x20000
  s_mul_i32 s58, s22, 786432
  s_add_u32 s44, s16, s58
  s_addc_u32 s45, s17, 0
  s_and_b32 s45, s45, 0xffff
  s_mov_b32 s46, 786432
  s_mov_b32 s47, 0x20000
  s_mul_i32 s58, s22, 73728
  s_add_u32 s58, s58, 26214400
  s_add_u32 s68, s20, s58
  s_addc_u32 s69, s21, 0
  s_and_b32 s69, s69, 0xffff
  s_mov_b32 s70, 73728
  s_mov_b32 s71, 0x20000
  s_waitcnt lgkmcnt(0)
  v_readfirstlane_b32 s54, v250
  v_readfirstlane_b32 s62, v251
  v_mfma_f32_32x32x16_bf16 v[64:79], v[208:211], v[216:219], v[64:79]
  ds_read_b64_tr_b16 v[244:245], v8 offset:2048
  ds_read_b64_tr_b16 v[246:247], v8 offset:3072
  v_mfma_f32_32x32x16_bf16 v[80:95], v[208:211], v[220:223], v[80:95]
  ds_read_b64_tr_b16 v[216:217], v7 offset:6144
  ds_read_b64_tr_b16 v[218:219], v7 offset:7168
  v_mfma_f32_32x32x16_bf16 v[96:111], v[208:211], v[224:227], v[96:111]
  ds_read_b64_tr_b16 v[220:221], v8 offset:6144
  ds_read_b64_tr_b16 v[222:223], v8 offset:7168
  v_mfma_f32_32x32x16_bf16 v[112:127], v[208:211], v[228:231], v[112:127]
  ds_read_b64_tr_b16 v[224:225], v7 offset:10240
  ds_read_b64_tr_b16 v[226:227], v7 offset:11264
  v_mfma_f32_32x32x16_bf16 v[128:143], v[208:211], v[232:235], v[128:143]
  ds_read_b64_tr_b16 v[228:229], v8 offset:10240
  ds_read_b64_tr_b16 v[230:231], v8 offset:11264
  v_mfma_f32_32x32x16_bf16 v[144:159], v[208:211], v[236:239], v[144:159]
  s_waitcnt lgkmcnt(6)
  v_mfma_f32_32x32x16_bf16 v[64:79], v[212:215], v[240:243], v[64:79]
  v_mfma_f32_32x32x16_bf16 v[80:95], v[212:215], v[244:247], v[80:95]
  v_mfma_f32_32x32x16_bf16 v[96:111], v[212:215], v[216:219], v[96:111]
  s_waitcnt lgkmcnt(0)
  v_mfma_f32_32x32x16_bf16 v[112:127], v[212:215], v[220:223], v[112:127]
  s_nop 7
  v_cvt_pk_bf16_f32 v64, v64, v65
  v_cvt_pk_bf16_f32 v65, v66, v67
  v_cvt_pk_bf16_f32 v66, v68, v69
  v_cvt_pk_bf16_f32 v67, v70, v71
  v_cvt_pk_bf16_f32 v68, v72, v73
  v_cvt_pk_bf16_f32 v69, v74, v75
  v_cvt_pk_bf16_f32 v70, v76, v77
  v_cvt_pk_bf16_f32 v71, v78, v79
  v_mfma_f32_32x32x16_bf16 v[128:143], v[212:215], v[224:227], v[128:143]
  v_cvt_pk_bf16_f32 v72, v80, v81
  v_cvt_pk_bf16_f32 v73, v82, v83
  v_cvt_pk_bf16_f32 v74, v84, v85
  v_cvt_pk_bf16_f32 v75, v86, v87
  v_cvt_pk_bf16_f32 v76, v88, v89
  v_cvt_pk_bf16_f32 v77, v90, v91
  v_cvt_pk_bf16_f32 v78, v92, v93
  v_cvt_pk_bf16_f32 v79, v94, v95
  v_mfma_f32_32x32x16_bf16 v[144:159], v[212:215], v[228:231], v[144:159]
  v_cvt_pk_bf16_f32 v80, v96, v97
  v_cvt_pk_bf16_f32 v81, v98, v99
  v_cvt_pk_bf16_f32 v82, v100, v101
  v_cvt_pk_bf16_f32 v83, v102, v103
  v_cvt_pk_bf16_f32 v84, v104, v105
  v_cvt_pk_bf16_f32 v85, v106, v107
  v_cvt_pk_bf16_f32 v86, v108, v109
  v_cvt_pk_bf16_f32 v87, v110, v111
  v_cvt_pk_bf16_f32 v88, v112, v113
  v_cvt_pk_bf16_f32 v89, v114, v115
  v_cvt_pk_bf16_f32 v90, v116, v117
  v_cvt_pk_bf16_f32 v91, v118, v119
  v_cvt_pk_bf16_f32 v92, v120, v121
  v_cvt_pk_bf16_f32 v93, v122, v123
  v_cvt_pk_bf16_f32 v94, v124, v125
  v_cvt_pk_bf16_f32 v95, v126, v127
  v_cvt_pk_bf16_f32 v96, v128, v129
  v_cvt_pk_bf16_f32 v97, v130, v131
  v_cvt_pk_bf16_f32 v98, v132, v133
  v_cvt_pk_bf16_f32 v99, v134, v135
  v_cvt_pk_bf16_f32 v100, v136, v137
  v_cvt_pk_bf16_f32 v101, v138, v139
  v_cvt_pk_bf16_f32 v102, v140, v141
  v_cvt_pk_bf16_f32 v103, v142, v143
  v_cvt_pk_bf16_f32 v104, v144, v145
  v_cvt_pk_bf16_f32 v105, v146, v147
  v_cvt_pk_bf16_f32 v106, v148, v149
  v_cvt_pk_bf16_f32 v107, v150, v151
  v_cvt_pk_bf16_f32 v108, v152, v153
  v_cvt_pk_bf16_f32 v109, v154, v155
  v_cvt_pk_bf16_f32 v110, v156, v157
  v_cvt_pk_bf16_f32 v111, v158, v159
  v_add_f32 v12, v12, v13
  v_and_b32 v176, 31, v1
  v_lshrrev_b32 v177, 5, v1
  v_lshrrev_b32 v178, 1, v176
  v_and_b32 v178, 7, v178
  v_lshlrev_b32 v179, 7, v176
  v_add_u32 v179, 0, v179
  v_add_u32 v180, 0, v177
  v_xor_b32 v180, v180, v178
  v_lshl_add_u32 v2, v180, 4, v179
  v_add_u32 v180, 2, v177
  v_xor_b32 v180, v180, v178
  v_lshl_add_u32 v3, v180, 4, v179
  v_add_u32 v180, 4, v177
  v_xor_b32 v180, v180, v178
  v_lshl_add_u32 v4, v180, 4, v179
  v_add_u32 v180, 6, v177
  v_xor_b32 v180, v180, v178
  v_lshl_add_u32 v5, v180, 4, v179
  v_lshlrev_b32 v6, 2, v176
  v_add_u32 v6, 136192, v6
  s_lshl_b32 s57, s24, 11
  v_add_u32 v14, s57, v11
  s_mul_i32 s57, s24, 12288
  v_add_u32 v13, s57, v11
  v_and_b32 v250, 3, v1
  v_mov_b32 v251, 0x3f80
  v_mov_b32 v252, 0x3f800000
  v_cmp_eq_u32 vcc, 0, v250
  s_nop 1
  v_cndmask_b32 v206, 0, v251, vcc
  v_cmp_eq_u32 vcc, 1, v250
  s_nop 1
  v_cndmask_b32 v206, v206, v252, vcc
  v_cmp_eq_u32 vcc, 2, v250
  s_nop 1
  v_cndmask_b32 v207, 0, v251, vcc
  v_cmp_eq_u32 vcc, 3, v250
  s_nop 1
  v_cndmask_b32 v207, v207, v252, vcc
  s_mul_i32 s57, s23, 9216
  s_mul_i32 s58, s24, 1536
  s_add_u32 s52, s57, s58
  v_lshlrev_b32 v204, 3, v1
  v_add_u32 v204, 1024, v204
  s_lshl_b32 s61, s24, 11
  s_mul_i32 s74, s23, 9
  s_lshl_b32 s60, s24, 1
  s_sub_u32 s74, s60, s74
  s_add_u32 s60, s74, 0
  s_cmp_lt_u32 s60, 9
  s_cbranch_scc1 L_own_0_0
  buffer_store_dwordx4 v[64:67], v11, s[40:43], s61 offen offset:0 sc1
  s_branch L_ownd_0_0
L_own_0_0:
  s_lshl_b32 s60, s60, 10
  s_add_u32 s60, s60, 98304
  v_add_u32 v252, s60, v11
  ds_write_b128 v252, v[64:67]
L_ownd_0_0:
  s_add_u32 s60, s74, 1
  s_cmp_lt_u32 s60, 9
  s_cbranch_scc1 L_own_0_1
  buffer_store_dwordx4 v[68:71], v11, s[40:43], s61 offen offset:1024 sc1
  s_branch L_ownd_0_1
L_own_0_1:
  s_lshl_b32 s60, s60, 10
  s_add_u32 s60, s60, 98304
  v_add_u32 v252, s60, v11
  ds_write_b128 v252, v[68:71]
L_ownd_0_1:
  s_barrier
  ds_read_b128 v[216:219], v2 offset:0
  ds_read_b128 v[220:223], v3 offset:0
  ds_read_b128 v[224:227], v4 offset:0
  ds_read_b128 v[228:231], v5 offset:0
  ds_read_b128 v[232:235], v2 offset:4096
  ds_read_b128 v[236:239], v3 offset:4096
  ds_read_b128 v[240:243], v4 offset:4096
  s_waitcnt lgkmcnt(4)
  v_mfma_f32_32x32x16_bf16 v[160:175], v[16:19], v[216:219], 0
  ds_read_b128 v[244:247], v5 offset:4096
  v_mfma_f32_32x32x16_bf16 v[160:175], v[20:23], v[220:223], v[160:175]
  ds_read_b128 v[216:219], v2 offset:8192
  s_add_u32 s61, s61, 12288
  v_mfma_f32_32x32x16_bf16 v[160:175], v[24:27], v[224:227], v[160:175]
  ds_read_b128 v[220:223], v3 offset:8192
  s_waitcnt lgkmcnt(4)
  v_mfma_f32_32x32x16_bf16 v[160:175], v[28:31], v[228:231], v[160:175]
  ds_read_b128 v[224:227], v4 offset:8192
  s_add_u32 s60, s74, 12
  s_cmp_lt_u32 s60, 9
  s_cbranch_scc1 L_own_1_0
  buffer_store_dwordx4 v[72:75], v11, s[40:43], s61 offen offset:0 sc1
  s_branch L_ownd_1_0
L_own_1_0:
  s_lshl_b32 s60, s60, 10
  s_add_u32 s60, s60, 98304
  v_add_u32 v252, s60, v11
  ds_write_b128 v252, v[72:75]
L_ownd_1_0:
  v_mfma_f32_32x32x16_bf16 v[160:175], v[32:35], v[232:235], v[160:175]
  ds_read_b128 v[228:231], v5 offset:8192
  v_mfma_f32_32x32x16_bf16 v[160:175], v[36:39], v[236:239], v[160:175]
  s_add_u32 s60, s74, 13
  s_cmp_lt_u32 s60, 9
  s_cbranch_scc1 L_own_1_1
  buffer_store_dwordx4 v[76:79], v11, s[40:43], s61 offen offset:1024 sc1
  s_branch L_ownd_1_1
L_own_1_1:
  s_lshl_b32 s60, s60, 10
  s_add_u32 s60, s60, 98304
  v_add_u32 v252, s60, v11
  ds_write_b128 v252, v[76:79]
L_ownd_1_1:
  s_waitcnt lgkmcnt(3)
  v_mfma_f32_32x32x16_bf16 v[160:175], v[40:43], v[240:243], v[160:175]
  s_add_u32 s61, s61, 12288
  v_mfma_f32_32x32x16_bf16 v[160:175], v[44:47], v[244:247], v[160:175]
  v_mfma_f32_32x32x16_bf16 v[160:175], v[48:51], v[216:219], v[160:175]
  s_add_u32 s60, s74, 24
  s_cmp_lt_u32 s60, 9
  s_cbranch_scc1 L_own_2_0
  buffer_store_dwordx4 v[80:83], v11, s[40:43], s61 offen offset:0 sc1
  s_branch L_ownd_2_0
L_own_2_0:
  s_lshl_b32 s60, s60, 10
  s_add_u32 s60, s60, 98304
  v_add_u32 v252, s60, v11
  ds_write_b128 v252, v[80:83]
L_ownd_2_0:
  s_waitcnt lgkmcnt(0)
  v_mfma_f32_32x32x16_bf16 v[160:175], v[52:55], v[220:223], v[160:175]
  v_mfma_f32_32x32x16_bf16 v[160:175], v[56:59], v[224:227], v[160:175]
  s_add_u32 s60, s74, 25
  s_cmp_lt_u32 s60, 9
  s_cbranch_scc1 L_own_2_1
  buffer_store_dwordx4 v[84:87], v11, s[40:43], s61 offen offset:1024 sc1
  s_branch L_ownd_2_1
L_own_2_1:
  s_lshl_b32 s60, s60, 10
  s_add_u32 s60, s60, 98304
  v_add_u32 v252, s60, v11
  ds_write_b128 v252, v[84:87]
L_ownd_2_1:
  v_mfma_f32_32x32x16_bf16 v[160:175], v[60:63], v[228:231], v[160:175]
  s_add_u32 s61, s61, 12288
  v_add_u32 v2, 12288, v2
  v_add_u32 v3, 12288, v3
  v_add_u32 v4, 12288, v4
  v_add_u32 v5, 12288, v5
  s_barrier
  ds_read_b128 v[232:235], v2 offset:0
  ds_read_b128 v[236:239], v3 offset:0
  ds_read_b128 v[240:243], v4 offset:0
  ds_read_b128 v[244:247], v5 offset:0
  ds_read_b128 v[216:219], v2 offset:4096
  ds_read_b128 v[220:223], v3 offset:4096
  ds_read_b128 v[224:227], v4 offset:4096
  s_barrier
  ds_read_b32 v249, v6 offset:0
  s_waitcnt lgkmcnt(5)
  v_mfma_f32_32x32x16_bf16 v[176:191], v[16:19], v[232:235], 0
  ds_read_b128 v[228:231], v5 offset:4096
  s_add_u32 s60, s74, 36
  s_cmp_lt_u32 s60, 9
  s_cbranch_scc1 L_own_3_0
  buffer_store_dwordx4 v[88:91], v11, s[40:43], s61 offen offset:0 sc1
  s_branch L_ownd_3_0
L_own_3_0:
  s_lshl_b32 s60, s60, 10
  s_add_u32 s60, s60, 98304
  v_add_u32 v252, s60, v11
  ds_write_b128 v252, v[88:91]
L_ownd_3_0:
  v_mfma_f32_32x32x16_bf16 v[176:191], v[20:23], v[236:239], v[176:191]
  ds_read_b128 v[232:235], v2 offset:8192
  s_waitcnt lgkmcnt(2)
  v_add_f32 v160, v160, v249
  v_add_f32 v161, v161, v249
  v_add_f32 v162, v162, v249
  v_add_f32 v163, v163, v249
  s_add_u32 s60, s74, 37
  s_cmp_lt_u32 s60, 9
  s_cbranch_scc1 L_own_3_1
  buffer_store_dwordx4 v[92:95], v11, s[40:43], s61 offen offset:1024 sc1
  s_branch L_ownd_3_1
L_own_3_1:
  s_lshl_b32 s60, s60, 10
  s_add_u32 s60, s60, 98304
  v_add_u32 v252, s60, v11
  ds_write_b128 v252, v[92:95]
L_ownd_3_1:
  v_mfma_f32_32x32x16_bf16 v[176:191], v[24:27], v[240:243], v[176:191]
  ds_read_b128 v[236:239], v3 offset:8192
  v_add_f32 v164, v164, v249
  v_add_f32 v165, v165, v249
  v_add_f32 v166, v166, v249
  v_add_f32 v167, v167, v249
  v_add_f32 v168, v168, v249
  s_add_u32 s61, s61, 12288
  v_mfma_f32_32x32x16_bf16 v[176:191], v[28:31], v[244:247], v[176:191]
  ds_read_b128 v[240:243], v4 offset:8192
  v_add_f32 v169, v169, v249
  v_add_f32 v170, v170, v249
  v_add_f32 v171, v171, v249
  v_add_f32 v172, v172, v249
  v_add_f32 v173, v173, v249
  s_add_u32 s60, s74, 48
  s_cmp_lt_u32 s60, 9
  s_cbranch_scc1 L_own_4_0
  buffer_store_dwordx4 v[96:99], v11, s[40:43], s61 offen offset:0 sc1
  s_branch L_ownd_4_0
L_own_4_0:
  s_lshl_b32 s60, s60, 10
  s_add_u32 s60, s60, 98304
  v_add_u32 v252, s60, v11
  ds_write_b128 v252, v[96:99]
L_ownd_4_0:
  v_mfma_f32_32x32x16_bf16 v[176:191], v[32:35], v[216:219], v[176:191]
  ds_read_b128 v[244:247], v5 offset:8192
  v_add_f32 v174, v174, v249
  v_add_f32 v175, v175, v249
  v_fma_f32 v160, v160, v248, -4.0
  v_fma_f32 v161, v161, v248, -4.0
  v_fma_f32 v162, v162, v248, -4.0
  v_add_u32 v2, 12288, v2
  v_add_u32 v3, 12288, v3
  v_add_u32 v4, 12288, v4
  v_add_u32 v5, 12288, v5
  s_add_u32 s60, s74, 49
  s_cmp_lt_u32 s60, 9
  s_cbranch_scc1 L_own_4_1
  buffer_store_dwordx4 v[100:103], v11, s[40:43], s61 offen offset:1024 sc1
  s_branch L_ownd_4_1
L_own_4_1:
  s_lshl_b32 s60, s60, 10
  s_add_u32 s60, s60, 98304
  v_add_u32 v252, s60, v11
  ds_write_b128 v252, v[100:103]
L_ownd_4_1:
  v_mfma_f32_32x32x16_bf16 v[176:191], v[36:39], v[220:223], v[176:191]
  ds_read_b128 v[216:219], v2 offset:0
  v_fma_f32 v163, v163, v248, -4.0
  v_fma_f32 v164, v164, v248, -4.0
  v_fma_f32 v165, v165, v248, -4.0
  v_fma_f32 v166, v166, v248, -4.0
  v_fma_f32 v167, v167, v248, -4.0
  s_add_u32 s61, s61, 12288
  s_waitcnt lgkmcnt(4)
  v_mfma_f32_32x32x16_bf16 v[176:191], v[40:43], v[224:227], v[176:191]
  ds_read_b128 v[220:223], v3 offset:0
  v_fma_f32 v168, v168, v248, -4.0
  v_fma_f32 v169, v169, v248, -4.0
  v_fma_f32 v170, v170, v248, -4.0
  v_fma_f32 v171, v171, v248, -4.0
  v_fma_f32 v172, v172, v248, -4.0
  v_fma_f32 v173, v173, v248, -4.0
  s_add_u32 s60, s74, 60
  s_cmp_lt_u32 s60, 9
  s_cbranch_scc1 L_own_5_0
  buffer_store_dwordx4 v[104:107], v11, s[40:43], s61 offen offset:0 sc1
  s_branch L_ownd_5_0
L_own_5_0:
  s_lshl_b32 s60, s60, 10
  s_add_u32 s60, s60, 98304
  v_add_u32 v252, s60, v11
  ds_write_b128 v252, v[104:107]
L_ownd_5_0:
  v_mfma_f32_32x32x16_bf16 v[176:191], v[44:47], v[228:231], v[176:191]
  ds_read_b128 v[224:227], v4 offset:0
  v_fma_f32 v174, v174, v248, -4.0
  v_fma_f32 v175, v175, v248, -4.0
  v_exp_f32 v160, v160
  v_exp_f32 v161, v161
  v_exp_f32 v162, v162
  s_add_u32 s60, s74, 61
  s_cmp_lt_u32 s60, 9
  s_cbranch_scc1 L_own_5_1
  buffer_store_dwordx4 v[108:111], v11, s[40:43], s61 offen offset:1024 sc1
  s_branch L_ownd_5_1
L_own_5_1:
  s_lshl_b32 s60, s60, 10
  s_add_u32 s60, s60, 98304
  v_add_u32 v252, s60, v11
  ds_write_b128 v252, v[108:111]
L_ownd_5_1:
  v_mfma_f32_32x32x16_bf16 v[176:191], v[48:51], v[232:235], v[176:191]
  ds_read_b128 v[228:231], v5 offset:0
  v_exp_f32 v163, v163
  v_exp_f32 v164, v164
  v_exp_f32 v165, v165
  v_exp_f32 v166, v166
  v_exp_f32 v167, v167
  v_lshlrev_b32 v251, 2, v1
  s_waitcnt lgkmcnt(4)
  v_mfma_f32_32x32x16_bf16 v[176:191], v[52:55], v[236:239], v[176:191]
  ds_read_b128 v[232:235], v2 offset:4096
  v_exp_f32 v168, v168
  v_exp_f32 v169, v169
  v_exp_f32 v170, v170
  v_exp_f32 v171, v171
  v_exp_f32 v172, v172
  s_lshl_b32 s61, s24, 8
  v_mfma_f32_32x32x16_bf16 v[176:191], v[56:59], v[240:243], v[176:191]
  ds_read_b128 v[236:239], v3 offset:4096
  v_exp_f32 v173, v173
  v_exp_f32 v174, v174
  v_exp_f32 v175, v175
  v_cvt_pk_bf16_f32 v208, v160, v161
  v_cvt_pk_bf16_f32 v209, v162, v163
  s_add_u32 s61, s61, 73728
  buffer_store_dword v12, v251, s[40:43], s61 offen sc1
  v_mfma_f32_32x32x16_bf16 v[176:191], v[60:63], v[244:247], v[176:191]
  ds_read_b128 v[240:243], v4 offset:4096
  v_cvt_pk_bf16_f32 v210, v164, v165
  v_cvt_pk_bf16_f32 v211, v166, v167
  v_cvt_pk_bf16_f32 v212, v168, v169
  v_cvt_pk_bf16_f32 v213, v170, v171
  v_cvt_pk_bf16_f32 v214, v172, v173
  v_cvt_pk_bf16_f32 v215, v174, v175
  ds_write_b128 v14, v[208:211] offset:0
  ds_write_b128 v14, v[212:215] offset:1024
  v_add_u32 v14, 12288, v14
  s_waitcnt lgkmcnt(0)
  s_barrier
  s_cmp_eq_u32 s24, 0
  s_cbranch_scc0 L_cpk_1
  ds_read_b128 v[64:67], v13 offset:0
  ds_read_b128 v[68:71], v13 offset:1024
  ds_read_b128 v[72:75], v13 offset:2048
  ds_read_b128 v[76:79], v13 offset:3072
  ds_read_b128 v[80:83], v13 offset:4096
  ds_read_b128 v[84:87], v13 offset:5120
  ds_read_b128 v[88:91], v13 offset:6144
  ds_read_b128 v[92:95], v13 offset:7168
  ds_read_b128 v[96:99], v13 offset:8192
  ds_read_b128 v[100:103], v13 offset:9216
  ds_read_b128 v[104:107], v13 offset:10240
  ds_read_b128 v[108:111], v13 offset:11264
  s_waitcnt lgkmcnt(0)
L_cpk_1:
  ds_read_b32 v249, v6 offset:128
  v_mfma_f32_32x32x16_bf16 v[160:175], v[16:19], v[216:219], 0
  ds_read_b128 v[244:247], v5 offset:4096
  v_mfma_f32_32x32x16_bf16 v[160:175], v[20:23], v[220:223], v[160:175]
  ds_read_b128 v[216:219], v2 offset:8192
  s_waitcnt lgkmcnt(2)
  v_add_f32 v176, v176, v249
  v_add_f32 v177, v177, v249
  v_add_f32 v178, v178, v249
  v_add_f32 v179, v179, v249
  v_mfma_f32_32x32x16_bf16 v[160:175], v[24:27], v[224:227], v[160:175]
  ds_read_b128 v[220:223], v3 offset:8192
  v_add_f32 v180, v180, v249
  v_add_f32 v181, v181, v249
  v_add_f32 v182, v182, v249
  v_add_f32 v183, v183, v249
  v_add_f32 v184, v184, v249
  v_mfma_f32_32x32x16_bf16 v[160:175], v[28:31], v[228:231], v[160:175]
  ds_read_b128 v[224:227], v4 offset:8192
  v_add_f32 v185, v185, v249
  v_add_f32 v186, v186, v249
  v_add_f32 v187, v187, v249
  v_add_f32 v188, v188, v249
  v_add_f32 v189, v189, v249
  v_mfma_f32_32x32x16_bf16 v[160:175], v[32:35], v[232:235], v[160:175]
  ds_read_b128 v[228:231], v5 offset:8192
  v_add_f32 v190, v190, v249
  v_add_f32 v191, v191, v249
  v_fma_f32 v176, v176, v248, -4.0
  v_fma_f32 v177, v177, v248, -4.0
  v_fma_f32 v178, v178, v248, -4.0
  v_add_u32 v2, 12288, v2
  v_add_u32 v3, 12288, v3
  v_add_u32 v4, 12288, v4
  v_add_u32 v5, 12288, v5
  v_mfma_f32_32x32x16_bf16 v[160:175], v[36:39], v[236:239], v[160:175]
  ds_read_b128 v[232:235], v2 offset:0
  v_fma_f32 v179, v179, v248, -4.0
  v_fma_f32 v180, v180, v248, -4.0
  v_fma_f32 v181, v181, v248, -4.0
  v_fma_f32 v182, v182, v248, -4.0
  v_fma_f32 v183, v183, v248, -4.0
  s_waitcnt lgkmcnt(4)
  v_mfma_f32_32x32x16_bf16 v[160:175], v[40:43], v[240:243], v[160:175]
  ds_read_b128 v[236:239], v3 offset:0
  v_fma_f32 v184, v184, v248, -4.0
  v_fma_f32 v185, v185, v248, -4.0
  v_fma_f32 v186, v186, v248, -4.0
  v_fma_f32 v187, v187, v248, -4.0
  v_fma_f32 v188, v188, v248, -4.0
  v_fma_f32 v189, v189, v248, -4.0
  v_mfma_f32_32x32x16_bf16 v[160:175], v[44:47], v[244:247], v[160:175]
  ds_read_b128 v[240:243], v4 offset:0
  v_fma_f32 v190, v190, v248, -4.0
  v_fma_f32 v191, v191, v248, -4.0
  v_exp_f32 v176, v176
  v_exp_f32 v177, v177
  v_exp_f32 v178, v178
  v_mfma_f32_32x32x16_bf16 v[160:175], v[48:51], v[216:219], v[160:175]
  ds_read_b128 v[244:247], v5 offset:0
  v_exp_f32 v179, v179
  v_exp_f32 v180, v180
  v_exp_f32 v181, v181
  v_exp_f32 v182, v182
  v_exp_f32 v183, v183
  s_waitcnt lgkmcnt(4)
  v_mfma_f32_32x32x16_bf16 v[160:175], v[52:55], v[220:223], v[160:175]
  ds_read_b128 v[216:219], v2 offset:4096
  v_exp_f32 v184, v184
  v_exp_f32 v185, v185
  v_exp_f32 v186, v186
  v_exp_f32 v187, v187
  v_exp_f32 v188, v188
  v_mfma_f32_32x32x16_bf16 v[160:175], v[56:59], v[224:227], v[160:175]
  ds_read_b128 v[220:223], v3 offset:4096
  v_exp_f32 v189, v189
  v_exp_f32 v190, v190
  v_exp_f32 v191, v191
  v_cvt_pk_bf16_f32 v208, v176, v177
  v_cvt_pk_bf16_f32 v209, v178, v179
  v_mfma_f32_32x32x16_bf16 v[160:175], v[60:63], v[228:231], v[160:175]
  ds_read_b128 v[224:227], v4 offset:4096
  v_cvt_pk_bf16_f32 v210, v180, v181
  v_cvt_pk_bf16_f32 v211, v182, v183
  v_cvt_pk_bf16_f32 v212, v184, v185
  v_cvt_pk_bf16_f32 v213, v186, v187
  v_cvt_pk_bf16_f32 v214, v188, v189
  v_cvt_pk_bf16_f32 v215, v190, v191
  ds_write_b128 v14, v[208:211] offset:0
  ds_write_b128 v14, v[212:215] offset:1024
  v_add_u32 v14, 12288, v14
  s_waitcnt vmcnt(0)
  v_mov_b32 v250, 137728
  v_mov_b32 v251, 1
  s_mov_b32 exec_lo, 1
  s_mov_b32 exec_hi, 0
  ds_add_rtn_u32 v252, v250, v251 offset:0
  s_waitcnt lgkmcnt(0)
  v_readfirstlane_b32 s57, v252
  s_nop 0
  s_cmp_eq_u32 s57, 5
  s_cbranch_scc0 L_sig_A
  s_lshl_b32 s57, s23, 2
  v_mov_b32 v250, s57
  v_mov_b32 v251, s54
  s_cmp_lg_u32 s62, 0
  s_cbranch_scc1 L_sigf_A
  global_store_dword v250, v251, s[26:27] offset:0 sc1
  s_branch L_sig_A
L_sigf_A:
  global_store_dword v250, v251, s[26:27] offset:256
L_sig_A:
  s_mov_b64 exec, -1
  s_waitcnt lgkmcnt(0)
  s_barrier
  s_cmp_eq_u32 s24, 1
  s_cbranch_scc0 L_cpk_2
  ds_read_b128 v[64:67], v13 offset:0
  ds_read_b128 v[68:71], v13 offset:1024
  ds_read_b128 v[72:75], v13 offset:2048
  ds_read_b128 v[76:79], v13 offset:3072
  ds_read_b128 v[80:83], v13 offset:4096
  ds_read_b128 v[84:87], v13 offset:5120
  ds_read_b128 v[88:91], v13 offset:6144
  ds_read_b128 v[92:95], v13 offset:7168
  ds_read_b128 v[96:99], v13 offset:8192
  ds_read_b128 v[100:103], v13 offset:9216
  ds_read_b128 v[104:107], v13 offset:10240
  ds_read_b128 v[108:111], v13 offset:11264
  s_waitcnt lgkmcnt(0)
L_cpk_2:
  ds_read_b32 v249, v6 offset:256
  v_mfma_f32_32x32x16_bf16 v[176:191], v[16:19], v[232:235], 0
  ds_read_b128 v[228:231], v5 offset:4096
  v_mfma_f32_32x32x16_bf16 v[176:191], v[20:23], v[236:239], v[176:191]
  ds_read_b128 v[232:235], v2 offset:8192
  s_waitcnt lgkmcnt(2)
  v_add_f32 v160, v160, v249
  v_add_f32 v161, v161, v249
  v_add_f32 v162, v162, v249
  v_add_f32 v163, v163, v249
  v_mfma_f32_32x32x16_bf16 v[176:191], v[24:27], v[240:243], v[176:191]
  ds_read_b128 v[236:239], v3 offset:8192
  v_add_f32 v164, v164, v249
  v_add_f32 v165, v165, v249
  v_add_f32 v166, v166, v249
  v_add_f32 v167, v167, v249
  v_add_f32 v168, v168, v249
  v_mfma_f32_32x32x16_bf16 v[176:191], v[28:31], v[244:247], v[176:191]
  ds_read_b128 v[240:243], v4 offset:8192
  v_add_f32 v169, v169, v249
  v_add_f32 v170, v170, v249
  v_add_f32 v171, v171, v249
  v_add_f32 v172, v172, v249
  v_add_f32 v173, v173, v249
  v_mfma_f32_32x32x16_bf16 v[176:191], v[32:35], v[216:219], v[176:191]
  ds_read_b128 v[244:247], v5 offset:8192
  v_add_f32 v174, v174, v249
  v_add_f32 v175, v175, v249
  v_fma_f32 v160, v160, v248, -4.0
  v_fma_f32 v161, v161, v248, -4.0
  v_fma_f32 v162, v162, v248, -4.0
  v_add_u32 v2, 12288, v2
  v_add_u32 v3, 12288, v3
  v_add_u32 v4, 12288, v4
  v_add_u32 v5, 12288, v5
  v_mfma_f32_32x32x16_bf16 v[176:191], v[36:39], v[220:223], v[176:191]
  ds_read_b128 v[216:219], v2 offset:0
  v_fma_f32 v163, v163, v248, -4.0
  v_fma_f32 v164, v164, v248, -4.0
  v_fma_f32 v165, v165, v248, -4.0
  v_fma_f32 v166, v166, v248, -4.0
  v_fma_f32 v167, v167, v248, -4.0
  s_waitcnt lgkmcnt(4)
  v_mfma_f32_32x32x16_bf16 v[176:191], v[40:43], v[224:227], v[176:191]
  ds_read_b128 v[220:223], v3 offset:0
  v_fma_f32 v168, v168, v248, -4.0
  v_fma_f32 v169, v169, v248, -4.0
  v_fma_f32 v170, v170, v248, -4.0
  v_fma_f32 v171, v171, v248, -4.0
  v_fma_f32 v172, v172, v248, -4.0
  v_fma_f32 v173, v173, v248, -4.0
  v_mfma_f32_32x32x16_bf16 v[176:191], v[44:47], v[228:231], v[176:191]
  ds_read_b128 v[224:227], v4 offset:0
  v_fma_f32 v174, v174, v248, -4.0
  v_fma_f32 v175, v175, v248, -4.0
  v_exp_f32 v160, v160
  v_exp_f32 v161, v161
  v_exp_f32 v162, v162
  v_mfma_f32_32x32x16_bf16 v[176:191], v[48:51], v[232:235], v[176:191]
  ds_read_b128 v[228:231], v5 offset:0
  v_exp_f32 v163, v163
  v_exp_f32 v164, v164
  v_exp_f32 v165, v165
  v_exp_f32 v166, v166
  v_exp_f32 v167, v167
  s_waitcnt lgkmcnt(4)
  v_mfma_f32_32x32x16_bf16 v[176:191], v[52:55], v[236:239], v[176:191]
  ds_read_b128 v[232:235], v2 offset:4096
  v_exp_f32 v168, v168
  v_exp_f32 v169, v169
  v_exp_f32 v170, v170
  v_exp_f32 v171, v171
  v_exp_f32 v172, v172
  v_mfma_f32_32x32x16_bf16 v[176:191], v[56:59], v[240:243], v[176:191]
  ds_read_b128 v[236:239], v3 offset:4096
  v_exp_f32 v173, v173
  v_exp_f32 v174, v174
  v_exp_f32 v175, v175
  v_cvt_pk_bf16_f32 v208, v160, v161
  v_cvt_pk_bf16_f32 v209, v162, v163
  v_mfma_f32_32x32x16_bf16 v[176:191], v[60:63], v[244:247], v[176:191]
  ds_read_b128 v[240:243], v4 offset:4096
  v_cvt_pk_bf16_f32 v210, v164, v165
  v_cvt_pk_bf16_f32 v211, v166, v167
  v_cvt_pk_bf16_f32 v212, v168, v169
  v_cvt_pk_bf16_f32 v213, v170, v171
  v_cvt_pk_bf16_f32 v214, v172, v173
  v_cvt_pk_bf16_f32 v215, v174, v175
  ds_write_b128 v14, v[208:211] offset:0
  ds_write_b128 v14, v[212:215] offset:1024
  v_add_u32 v14, 12288, v14
  s_cmp_lg_u32 s24, 0
  s_cbranch_scc1 L_npa
  s_mov_b32 s63, 0
  v_and_b32 v250, 7, v1
  v_lshlrev_b32 v250, 2, v250
  v_and_b32 v251, 8, v1
  v_lshl_add_u32 v250, v251, 5, v250
L_poll_A:
  s_mov_b32 exec_lo, 0xffff
  s_mov_b32 exec_hi, 0
  global_load_dword v10, v250, s[26:27] offset:0 sc1
  s_mov_b64 exec, -1
  s_waitcnt vmcnt(0)
  v_cmp_eq_u32 vcc, s54, v10
  s_nop 1
  s_and_b32 s60, vcc_lo, 0xffff
  s_lshr_b32 s57, s60, 8
  s_or_b32 s60, s60, s57
  s_and_b32 s60, s60, 0xff
  s_cmp_eq_u32 s60, 0xff
  s_cbranch_scc1 L_polld_A
  s_add_u32 s63, s63, 1
  s_cmp_lt_u32 s63, 0x80000
  s_cbranch_scc1 L_poll_A
L_polld_A:
L_npa:
  s_waitcnt lgkmcnt(0)
  s_barrier
  s_cmp_eq_u32 s24, 2
  s_cbranch_scc0 L_cpk_3
  ds_read_b128 v[64:67], v13 offset:0
  ds_read_b128 v[68:71], v13 offset:1024
  ds_read_b128 v[72:75], v13 offset:2048
  ds_read_b128 v[76:79], v13 offset:3072
  ds_read_b128 v[80:83], v13 offset:4096
  ds_read_b128 v[84:87], v13 offset:5120
  ds_read_b128 v[88:91], v13 offset:6144
  ds_read_b128 v[92:95], v13 offset:7168
  ds_read_b128 v[96:99], v13 offset:8192
  ds_read_b128 v[100:103], v13 offset:9216
  ds_read_b128 v[104:107], v13 offset:10240
  ds_read_b128 v[108:111], v13 offset:11264
  s_waitcnt lgkmcnt(0)
L_cpk_3:
  ds_read_b32 v249, v6 offset:384
  v_mfma_f32_32x32x16_bf16 v[160:175], v[16:19], v[216:219], 0
  ds_read_b128 v[244:247], v5 offset:4096
  s_add_u32 s60, s23, 1
  s_and_b32 s60, s60, 7
  s_mul_i32 s60, s60, 98304
  s_add_u32 s59, s60, s52
  buffer_load_dwordx4 v[118:121], v11, s[44:47], s59 offen sc1
  buffer_load_dwordx2 v[122:123], v204, s[44:47], s59 offen sc1
  v_mfma_f32_32x32x16_bf16 v[160:175], v[20:23], v[220:223], v[160:175]
  ds_read_b128 v[216:219], v2 offset:8192
  s_waitcnt lgkmcnt(2)
  v_add_f32 v176, v176, v249
  v_add_f32 v177, v177, v249
  v_add_f32 v178, v178, v249
  v_add_f32 v179, v179, v249
  s_add_u32 s60, s23, 2
  s_and_b32 s60, s60, 7
  s_mul_i32 s60, s60, 98304
  s_add_u32 s59, s60, s52
  buffer_load_dwordx4 v[124:127], v11, s[44:47], s59 offen sc1
  buffer_load_dwordx2 v[128:129], v204, s[44:47], s59 offen sc1
  v_mfma_f32_32x32x16_bf16 v[160:175], v[24:27], v[224:227], v[160:175]
  ds_read_b128 v[220:223], v3 offset:8192
  v_add_f32 v180, v180, v249
  v_add_f32 v181, v181, v249
  v_add_f32 v182, v182, v249
  v_add_f32 v183, v183, v249
  v_add_f32 v184, v184, v249
  s_add_u32 s60, s23, 3
  s_and_b32 s60, s60, 7
  s_mul_i32 s60, s60, 98304
  s_add_u32 s59, s60, s52
  buffer_load_dwordx4 v[130:133], v11, s[44:47], s59 offen sc1
  buffer_load_dwordx2 v[134:135], v204, s[44:47], s59 offen sc1
  v_mfma_f32_32x32x16_bf16 v[160:175], v[28:31], v[228:231], v[160:175]
  ds_read_b128 v[224:227], v4 offset:8192
  v_add_f32 v185, v185, v249
  v_add_f32 v186, v186, v249
  v_add_f32 v187, v187, v249
  v_add_f32 v188, v188, v249
  v_add_f32 v189, v189, v249
  s_add_u32 s60, s23, 4
  s_and_b32 s60, s60, 7
  s_mul_i32 s60, s60, 98304
  s_add_u32 s59, s60, s52
  buffer_load_dwordx4 v[136:139], v11, s[44:47], s59 offen sc1
  buffer_load_dwordx2 v[140:141], v204, s[44:47], s59 offen sc1
  v_mfma_f32_32x32x16_bf16 v[160:175], v[32:35], v[232:235], v[160:175]
  ds_read_b128 v[228:231], v5 offset:8192
  v_add_f32 v190, v190, v249
  v_add_f32 v191, v191, v249
  v_fma_f32 v176, v176, v248, -4.0
  v_fma_f32 v177, v177, v248, -4.0
  v_fma_f32 v178, v178, v248, -4.0
  v_add_u32 v2, 12288, v2
  v_add_u32 v3, 12288, v3
  v_add_u32 v4, 12288, v4
  v_add_u32 v5, 12288, v5
  s_add_u32 s60, s23, 5
  s_and_b32 s60, s60, 7
  s_mul_i32 s60, s60, 98304
  s_add_u32 s59, s60, s52
  buffer_load_dwordx4 v[142:145], v11, s[44:47], s59 offen sc1
  buffer_load_dwordx2 v[146:147], v204, s[44:47], s59 offen sc1
  v_mfma_f32_32x32x16_bf16 v[160:175], v[36:39], v[236:239], v[160:175]
  ds_read_b128 v[232:235], v2 offset:0
  v_fma_f32 v179, v179, v248, -4.0
  v_fma_f32 v180, v180, v248, -4.0
  v_fma_f32 v181, v181, v248, -4.0
  v_fma_f32 v182, v182, v248, -4.0
  v_fma_f32 v183, v183, v248, -4.0
  s_add_u32 s60, s23, 6
  s_and_b32 s60, s60, 7
  s_mul_i32 s60, s60, 98304
  s_add_u32 s59, s60, s52
  buffer_load_dwordx4 v[148:151], v11, s[44:47], s59 offen sc1
  buffer_load_dwordx2 v[152:153], v204, s[44:47], s59 offen sc1
  s_waitcnt lgkmcnt(4)
  v_mfma_f32_32x32x16_bf16 v[160:175], v[40:43], v[240:243], v[160:175]
  ds_read_b128 v[236:239], v3 offset:0
  v_fma_f32 v184, v184, v248, -4.0
  v_fma_f32 v185, v185, v248, -4.0
  v_fma_f32 v186, v186, v248, -4.0
  v_fma_f32 v187, v187, v248, -4.0
  v_fma_f32 v188, v188, v248, -4.0
  v_fma_f32 v189, v189, v248, -4.0
  s_add_u32 s60, s23, 7
  s_and_b32 s60, s60, 7
  s_mul_i32 s60, s60, 98304
  s_add_u32 s59, s60, s52
  buffer_load_dwordx4 v[154:157], v11, s[44:47], s59 offen sc1
  buffer_load_dwordx2 v[158:159], v204, s[44:47], s59 offen sc1
  v_mfma_f32_32x32x16_bf16 v[160:175], v[44:47], v[244:247], v[160:175]
  ds_read_b128 v[240:243], v4 offset:0
  v_fma_f32 v190, v190, v248, -4.0
  v_fma_f32 v191, v191, v248, -4.0
  v_exp_f32 v176, v176
  v_exp_f32 v177, v177
  v_exp_f32 v178, v178
  s_mul_i32 s60, s24, 1536
  s_add_u32 s60, s60, 98304
  v_add_u32 v250, s60, v11
  v_add_u32 v251, s60, v204
  ds_read_b128 v[112:115], v250
  ds_read_b64 v[116:117], v251
  v_mfma_f32_32x32x16_bf16 v[160:175], v[48:51], v[216:219], v[160:175]
  ds_read_b128 v[244:247], v5 offset:0
  v_exp_f32 v179, v179
  v_exp_f32 v180, v180
  v_exp_f32 v181, v181
  v_exp_f32 v182, v182
  v_exp_f32 v183, v183
  v_lshlrev_b32 v10, 2, v1
  s_lshl_b32 s59, s24, 8
  s_add_u32 s59, s59, 73728
  buffer_load_dword v7, v10, s[44:47], s59 offen sc1
  s_add_u32 s59, s59, 98304
  buffer_load_dword v8, v10, s[44:47], s59 offen sc1
  s_waitcnt lgkmcnt(6)
  v_mfma_f32_32x32x16_bf16 v[160:175], v[52:55], v[220:223], v[160:175]
  ds_read_b128 v[216:219], v2 offset:4096
  v_exp_f32 v184, v184
  v_exp_f32 v185, v185
  v_exp_f32 v186, v186
  v_exp_f32 v187, v187
  v_exp_f32 v188, v188
  s_add_u32 s59, s59, 98304
  buffer_load_dword v9, v10, s[44:47], s59 offen sc1
  s_add_u32 s59, s59, 98304
  buffer_load_dword v205, v10, s[44:47], s59 offen sc1
  s_add_u32 s59, s59, 98304
  buffer_load_dword v12, v10, s[44:47], s59 offen sc1
  v_mfma_f32_32x32x16_bf16 v[160:175], v[56:59], v[224:227], v[160:175]
  ds_read_b128 v[220:223], v3 offset:4096
  v_exp_f32 v189, v189
  v_exp_f32 v190, v190
  v_exp_f32 v191, v191
  v_cvt_pk_bf16_f32 v208, v176, v177
  v_cvt_pk_bf16_f32 v209, v178, v179
  s_add_u32 s59, s59, 98304
  buffer_load_dword v15, v10, s[44:47], s59 offen sc1
  s_add_u32 s59, s59, 98304
  buffer_load_dword v252, v10, s[44:47], s59 offen sc1
  s_add_u32 s59, s59, 98304
  buffer_load_dword v253, v10, s[44:47], s59 offen sc1
  v_mfma_f32_32x32x16_bf16 v[160:175], v[60:63], v[228:231], v[160:175]
  ds_read_b128 v[224:227], v4 offset:4096
  v_cvt_pk_bf16_f32 v210, v180, v181
  v_cvt_pk_bf16_f32 v211, v182, v183
  v_cvt_pk_bf16_f32 v212, v184, v185
  v_cvt_pk_bf16_f32 v213, v186, v187
  v_cvt_pk_bf16_f32 v214, v188, v189
  v_cvt_pk_bf16_f32 v215, v190, v191
  ds_write_b128 v14, v[208:211] offset:0
  ds_write_b128 v14, v[212:215] offset:1024
  v_add_u32 v14, 12288, v14
  s_waitcnt lgkmcnt(0)
  s_barrier
  s_cmp_eq_u32 s24, 3
  s_cbranch_scc0 L_cpk_4
  ds_read_b128 v[64:67], v13 offset:0
  ds_read_b128 v[68:71], v13 offset:1024
  ds_read_b128 v[72:75], v13 offset:2048
  ds_read_b128 v[76:79], v13 offset:3072
  ds_read_b128 v[80:83], v13 offset:4096
  ds_read_b128 v[84:87], v13 offset:5120
  ds_read_b128 v[88:91], v13 offset:6144
  ds_read_b128 v[92:95], v13 offset:7168
  ds_read_b128 v[96:99], v13 offset:8192
  ds_read_b128 v[100:103], v13 offset:9216
  ds_read_b128 v[104:107], v13 offset:10240
  ds_read_b128 v[108:111], v13 offset:11264
  s_waitcnt lgkmcnt(0)
L_cpk_4:
  ds_read_b32 v249, v6 offset:512
  v_mfma_f32_32x32x16_bf16 v[176:191], v[16:19], v[232:235], 0
  ds_read_b128 v[228:231], v5 offset:4096
  s_waitcnt vmcnt(0)
  v_mfma_f32_4x4x4_16b_bf16 v[192:195], v[206:207], v[112:113], 0
  v_mfma_f32_32x32x16_bf16 v[176:191], v[20:23], v[236:239], v[176:191]
  ds_read_b128 v[232:235], v2 offset:8192
  s_waitcnt lgkmcnt(2)
  v_add_f32 v160, v160, v249
  v_add_f32 v161, v161, v249
  v_add_f32 v162, v162, v249
  v_add_f32 v163, v163, v249
  v_mfma_f32_4x4x4_16b_bf16 v[196:199], v[206:207], v[114:115], 0
  v_mfma_f32_4x4x4_16b_bf16 v[200:203], v[206:207], v[116:117], 0
  v_mfma_f32_32x32x16_bf16 v[176:191], v[24:27], v[240:243], v[176:191]
  ds_read_b128 v[236:239], v3 offset:8192
  v_add_f32 v164, v164, v249
  v_add_f32 v165, v165, v249
  v_add_f32 v166, v166, v249
  v_add_f32 v167, v167, v249
  v_add_f32 v168, v168, v249
  v_mfma_f32_4x4x4_16b_bf16 v[192:195], v[206:207], v[118:119], v[192:195]
  v_mfma_f32_4x4x4_16b_bf16 v[196:199], v[206:207], v[120:121], v[196:199]
  v_mfma_f32_32x32x16_bf16 v[176:191], v[28:31], v[244:247], v[176:191]
  ds_read_b128 v[240:243], v4 offset:8192
  v_add_f32 v169, v169, v249
  v_add_f32 v170, v170, v249
  v_add_f32 v171, v171, v249
  v_add_f32 v172, v172, v249
  v_add_f32 v173, v173, v249
  v_mfma_f32_4x4x4_16b_bf16 v[200:203], v[206:207], v[122:123], v[200:203]
  v_mfma_f32_4x4x4_16b_bf16 v[192:195], v[206:207], v[124:125], v[192:195]
  v_mfma_f32_4x4x4_16b_bf16 v[196:199], v[206:207], v[126:127], v[196:199]
  v_mfma_f32_32x32x16_bf16 v[176:191], v[32:35], v[216:219], v[176:191]
  ds_read_b128 v[244:247], v5 offset:8192
  v_add_f32 v174, v174, v249
  v_add_f32 v175, v175, v249
  v_fma_f32 v160, v160, v248, -4.0
  v_fma_f32 v161, v161, v248, -4.0
  v_fma_f32 v162, v162, v248, -4.0
  v_add_u32 v2, 12288, v2
  v_add_u32 v3, 12288, v3
  v_add_u32 v4, 12288, v4
  v_add_u32 v5, 12288, v5
  v_mfma_f32_4x4x4_16b_bf16 v[200:203], v[206:207], v[128:129], v[200:203]
  v_mfma_f32_4x4x4_16b_bf16 v[192:195], v[206:207], v[130:131], v[192:195]
  v_mfma_f32_32x32x16_bf16 v[176:191], v[36:39], v[220:223], v[176:191]
  ds_read_b128 v[216:219], v2 offset:0
  v_fma_f32 v163, v163, v248, -4.0
  v_fma_f32 v164, v164, v248, -4.0
  v_fma_f32 v165, v165, v248, -4.0
  v_fma_f32 v166, v166, v248, -4.0
  v_fma_f32 v167, v167, v248, -4.0
  v_mfma_f32_4x4x4_16b_bf16 v[196:199], v[206:207], v[132:133], v[196:199]
  v_mfma_f32_4x4x4_16b_bf16 v[200:203], v[206:207], v[134:135], v[200:203]
  s_waitcnt lgkmcnt(4)
  v_mfma_f32_32x32x16_bf16 v[176:191], v[40:43], v[224:227], v[176:191]
  ds_read_b128 v[220:223], v3 offset:0
  v_fma_f32 v168, v168, v248, -4.0
  v_fma_f32 v169, v169, v248, -4.0
  v_fma_f32 v170, v170, v248, -4.0
  v_fma_f32 v171, v171, v248, -4.0
  v_fma_f32 v172, v172, v248, -4.0
  v_fma_f32 v173, v173, v248, -4.0
  v_mfma_f32_4x4x4_16b_bf16 v[192:195], v[206:207], v[136:137], v[192:195]
  v_mfma_f32_4x4x4_16b_bf16 v[196:199], v[206:207], v[138:139], v[196:199]
  v_mfma_f32_32x32x16_bf16 v[176:191], v[44:47], v[228:231], v[176:191]
  ds_read_b128 v[224:227], v4 offset:0
  v_fma_f32 v174, v174, v248, -4.0
  v_fma_f32 v175, v175, v248, -4.0
  v_exp_f32 v160, v160
  v_exp_f32 v161, v161
  v_exp_f32 v162, v162
  v_mfma_f32_4x4x4_16b_bf16 v[200:203], v[206:207], v[140:141], v[200:203]
  v_mfma_f32_4x4x4_16b_bf16 v[192:195], v[206:207], v[142:143], v[192:195]
  v_mfma_f32_4x4x4_16b_bf16 v[196:199], v[206:207], v[144:145], v[196:199]
  v_mfma_f32_32x32x16_bf16 v[176:191], v[48:51], v[232:235], v[176:191]
  ds_read_b128 v[228:231], v5 offset:0
  v_exp_f32 v163, v163
  v_exp_f32 v164, v164
  v_exp_f32 v165, v165
  v_exp_f32 v166, v166
  v_exp_f32 v167, v167
  v_mfma_f32_4x4x4_16b_bf16 v[200:203], v[206:207], v[146:147], v[200:203]
  v_mfma_f32_4x4x4_16b_bf16 v[192:195], v[206:207], v[148:149], v[192:195]
  s_waitcnt lgkmcnt(4)
  v_mfma_f32_32x32x16_bf16 v[176:191], v[52:55], v[236:239], v[176:191]
  ds_read_b128 v[232:235], v2 offset:4096
  v_exp_f32 v168, v168
  v_exp_f32 v169, v169
  v_exp_f32 v170, v170
  v_exp_f32 v171, v171
  v_exp_f32 v172, v172
  v_mfma_f32_4x4x4_16b_bf16 v[196:199], v[206:207], v[150:151], v[196:199]
  v_mfma_f32_4x4x4_16b_bf16 v[200:203], v[206:207], v[152:153], v[200:203]
  v_mfma_f32_32x32x16_bf16 v[176:191], v[56:59], v[240:243], v[176:191]
  ds_read_b128 v[236:239], v3 offset:4096
  v_exp_f32 v173, v173
  v_exp_f32 v174, v174
  v_exp_f32 v175, v175
  v_cvt_pk_bf16_f32 v208, v160, v161
  v_cvt_pk_bf16_f32 v209, v162, v163
  v_mfma_f32_4x4x4_16b_bf16 v[192:195], v[206:207], v[154:155], v[192:195]
  v_mfma_f32_4x4x4_16b_bf16 v[196:199], v[206:207], v[156:157], v[196:199]
  v_mfma_f32_4x4x4_16b_bf16 v[200:203], v[206:207], v[158:159], v[200:203]
  v_mfma_f32_32x32x16_bf16 v[176:191], v[60:63], v[244:247], v[176:191]
  ds_read_b128 v[240:243], v4 offset:4096
  v_cvt_pk_bf16_f32 v210, v164, v165
  v_cvt_pk_bf16_f32 v211, v166, v167
  v_cvt_pk_bf16_f32 v212, v168, v169
  v_cvt_pk_bf16_f32 v213, v170, v171
  v_cvt_pk_bf16_f32 v214, v172, v173
  v_cvt_pk_bf16_f32 v215, v174, v175
  ds_write_b128 v14, v[208:211] offset:0
  ds_write_b128 v14, v[212:215] offset:1024
  v_add_u32 v14, 12288, v14
  v_cvt_pk_bf16_f32 v112, v192, v193
  v_cvt_pk_bf16_f32 v113, v194, v195
  v_cvt_pk_bf16_f32 v114, v196, v197
  v_cvt_pk_bf16_f32 v115, v198, v199
  v_cvt_pk_bf16_f32 v116, v200, v201
  v_cvt_pk_bf16_f32 v117, v202, v203
  buffer_store_dwordx4 v[112:115], v11, s[68:71], s52 offen sc1
  buffer_store_dwordx2 v[116:117], v204, s[68:71], s52 offen sc1
  v_add_f32 v7, v7, v8
  v_add_f32 v7, v7, v9
  v_add_f32 v7, v7, v205
  v_add_f32 v7, v7, v12
  v_add_f32 v7, v7, v15
  v_add_f32 v7, v7, v252
  v_add_f32 v7, v7, v253
  v_mov_b32 v8, v7
  s_nop 1
  v_permlane32_swap_b32 v7, v8
  s_nop 1
  v_add_f32 v7, v7, v8
  v_cvt_pk_bf16_f32 v7, v7, v7
  v_and_b32 v8, 31, v1
  v_lshlrev_b32 v8, 1, v8
  s_lshl_b32 s59, s24, 6
  s_add_u32 s59, s59, 137216
  v_add_u32 v8, s59, v8
  ds_write_b16 v8, v7
  s_waitcnt lgkmcnt(0)
  s_barrier
  s_cmp_eq_u32 s24, 4
  s_cbranch_scc0 L_cpk_5
  ds_read_b128 v[64:67], v13 offset:0
  ds_read_b128 v[68:71], v13 offset:1024
  ds_read_b128 v[72:75], v13 offset:2048
  ds_read_b128 v[76:79], v13 offset:3072
  ds_read_b128 v[80:83], v13 offset:4096
  ds_read_b128 v[84:87], v13 offset:5120
  ds_read_b128 v[88:91], v13 offset:6144
  ds_read_b128 v[92:95], v13 offset:7168
  ds_read_b128 v[96:99], v13 offset:8192
  ds_read_b128 v[100:103], v13 offset:9216
  ds_read_b128 v[104:107], v13 offset:10240
  ds_read_b128 v[108:111], v13 offset:11264
  s_waitcnt lgkmcnt(0)
L_cpk_5:
  ds_read_b32 v249, v6 offset:640
  v_mfma_f32_32x32x16_bf16 v[160:175], v[16:19], v[216:219], 0
  ds_read_b128 v[244:247], v5 offset:4096
  v_mfma_f32_32x32x16_bf16 v[160:175], v[20:23], v[220:223], v[160:175]
  ds_read_b128 v[216:219], v2 offset:8192
  s_waitcnt lgkmcnt(2)
  v_add_f32 v176, v176, v249
  v_add_f32 v177, v177, v249
  v_add_f32 v178, v178, v249
  v_add_f32 v179, v179, v249
  v_mfma_f32_32x32x16_bf16 v[160:175], v[24:27], v[224:227], v[160:175]
  ds_read_b128 v[220:223], v3 offset:8192
  v_add_f32 v180, v180, v249
  v_add_f32 v181, v181, v249
  v_add_f32 v182, v182, v249
  v_add_f32 v183, v183, v249
  v_add_f32 v184, v184, v249
  s_waitcnt vmcnt(0)
  v_mov_b32 v250, 137728
  v_mov_b32 v251, 1
  s_mov_b32 exec_lo, 1
  s_mov_b32 exec_hi, 0
  ds_add_rtn_u32 v252, v250, v251 offset:4
  s_waitcnt lgkmcnt(0)
  v_readfirstlane_b32 s57, v252
  s_nop 0
  s_cmp_eq_u32 s57, 5
  s_cbranch_scc0 L_sig_B
  s_lshl_b32 s57, s23, 2
  v_mov_b32 v250, s57
  v_mov_b32 v251, s54
  s_cmp_lg_u32 s62, 0
  s_cbranch_scc1 L_sigf_B
  global_store_dword v250, v251, s[26:27] offset:128 sc1
  s_branch L_sig_B
L_sigf_B:
  global_store_dword v250, v251, s[26:27] offset:384
L_sig_B:
  s_mov_b64 exec, -1
  v_mfma_f32_32x32x16_bf16 v[160:175], v[28:31], v[228:231], v[160:175]
  ds_read_b128 v[224:227], v4 offset:8192
  v_add_f32 v185, v185, v249
  v_add_f32 v186, v186, v249
  v_add_f32 v187, v187, v249
  v_add_f32 v188, v188, v249
  v_add_f32 v189, v189, v249
  v_mfma_f32_32x32x16_bf16 v[160:175], v[32:35], v[232:235], v[160:175]
  ds_read_b128 v[228:231], v5 offset:8192
  v_add_f32 v190, v190, v249
  v_add_f32 v191, v191, v249
  v_fma_f32 v176, v176, v248, -4.0
  v_fma_f32 v177, v177, v248, -4.0
  v_fma_f32 v178, v178, v248, -4.0
  v_add_u32 v2, 12288, v2
  v_add_u32 v3, 12288, v3
  v_add_u32 v4, 12288, v4
  v_add_u32 v5, 12288, v5
  v_mfma_f32_32x32x16_bf16 v[160:175], v[36:39], v[236:239], v[160:175]
  ds_read_b128 v[232:235], v2 offset:0
  v_fma_f32 v179, v179, v248, -4.0
  v_fma_f32 v180, v180, v248, -4.0
  v_fma_f32 v181, v181, v248, -4.0
  v_fma_f32 v182, v182, v248, -4.0
  v_fma_f32 v183, v183, v248, -4.0
  v_mfma_f32_32x32x16_bf16 v[160:175], v[40:43], v[240:243], v[160:175]
  ds_read_b128 v[236:239], v3 offset:0
  v_fma_f32 v184, v184, v248, -4.0
  v_fma_f32 v185, v185, v248, -4.0
  v_fma_f32 v186, v186, v248, -4.0
  v_fma_f32 v187, v187, v248, -4.0
  v_fma_f32 v188, v188, v248, -4.0
  v_fma_f32 v189, v189, v248, -4.0
  v_mfma_f32_32x32x16_bf16 v[160:175], v[44:47], v[244:247], v[160:175]
  ds_read_b128 v[240:243], v4 offset:0
  v_fma_f32 v190, v190, v248, -4.0
  v_fma_f32 v191, v191, v248, -4.0
  v_exp_f32 v176, v176
  v_exp_f32 v177, v177
  v_exp_f32 v178, v178
  v_mfma_f32_32x32x16_bf16 v[160:175], v[48:51], v[216:219], v[160:175]
  ds_read_b128 v[244:247], v5 offset:0
  v_exp_f32 v179, v179
  v_exp_f32 v180, v180
  v_exp_f32 v181, v181
  v_exp_f32 v182, v182
  v_exp_f32 v183, v183
  s_waitcnt lgkmcnt(4)
  v_mfma_f32_32x32x16_bf16 v[160:175], v[52:55], v[220:223], v[160:175]
  ds_read_b128 v[216:219], v2 offset:4096
  v_exp_f32 v184, v184
  v_exp_f32 v185, v185
  v_exp_f32 v186, v186
  v_exp_f32 v187, v187
  v_exp_f32 v188, v188
  v_mfma_f32_32x32x16_bf16 v[160:175], v[56:59], v[224:227], v[160:175]
  ds_read_b128 v[220:223], v3 offset:4096
  v_exp_f32 v189, v189
  v_exp_f32 v190, v190
  v_exp_f32 v191, v191
  v_cvt_pk_bf16_f32 v208, v176, v177
  v_cvt_pk_bf16_f32 v209, v178, v179
  v_mfma_f32_32x32x16_bf16 v[160:175], v[60:63], v[228:231], v[160:175]
  ds_read_b128 v[224:227], v4 offset:4096
  v_cvt_pk_bf16_f32 v210, v180, v181
  v_cvt_pk_bf16_f32 v211, v182, v183
  v_cvt_pk_bf16_f32 v212, v184, v185
  v_cvt_pk_bf16_f32 v213, v186, v187
  v_cvt_pk_bf16_f32 v214, v188, v189
  v_cvt_pk_bf16_f32 v215, v190, v191
  ds_write_b128 v14, v[208:211] offset:0
  ds_write_b128 v14, v[212:215] offset:1024
  v_add_u32 v14, 12288, v14
  s_waitcnt lgkmcnt(0)
  s_barrier
  s_cmp_eq_u32 s24, 5
  s_cbranch_scc0 L_cpk_6
  ds_read_b128 v[64:67], v13 offset:0
  ds_read_b128 v[68:71], v13 offset:1024
  ds_read_b128 v[72:75], v13 offset:2048
  ds_read_b128 v[76:79], v13 offset:3072
  ds_read_b128 v[80:83], v13 offset:4096
  ds_read_b128 v[84:87], v13 offset:5120
  ds_read_b128 v[88:91], v13 offset:6144
  ds_read_b128 v[92:95], v13 offset:7168
  ds_read_b128 v[96:99], v13 offset:8192
  ds_read_b128 v[100:103], v13 offset:9216
  ds_read_b128 v[104:107], v13 offset:10240
  ds_read_b128 v[108:111], v13 offset:11264
  s_waitcnt lgkmcnt(0)
L_cpk_6:
  ds_read_b32 v249, v6 offset:768
  v_mfma_f32_32x32x16_bf16 v[176:191], v[16:19], v[232:235], 0
  ds_read_b128 v[228:231], v5 offset:4096
  v_mfma_f32_32x32x16_bf16 v[176:191], v[20:23], v[236:239], v[176:191]
  ds_read_b128 v[232:235], v2 offset:8192
  s_waitcnt lgkmcnt(2)
  v_add_f32 v160, v160, v249
  v_add_f32 v161, v161, v249
  v_add_f32 v162, v162, v249
  v_add_f32 v163, v163, v249
  v_mfma_f32_32x32x16_bf16 v[176:191], v[24:27], v[240:243], v[176:191]
  ds_read_b128 v[236:239], v3 offset:8192
  v_add_f32 v164, v164, v249
  v_add_f32 v165, v165, v249
  v_add_f32 v166, v166, v249
  v_add_f32 v167, v167, v249
  v_add_f32 v168, v168, v249
  v_mfma_f32_32x32x16_bf16 v[176:191], v[28:31], v[244:247], v[176:191]
  ds_read_b128 v[240:243], v4 offset:8192
  v_add_f32 v169, v169, v249
  v_add_f32 v170, v170, v249
  v_add_f32 v171, v171, v249
  v_add_f32 v172, v172, v249
  v_add_f32 v173, v173, v249
  v_mfma_f32_32x32x16_bf16 v[176:191], v[32:35], v[216:219], v[176:191]
  ds_read_b128 v[244:247], v5 offset:8192
  v_add_f32 v174, v174, v249
  v_add_f32 v175, v175, v249
  v_fma_f32 v160, v160, v248, -4.0
  v_fma_f32 v161, v161, v248, -4.0
  v_fma_f32 v162, v162, v248, -4.0
  v_add_u32 v2, 12288, v2
  v_add_u32 v3, 12288, v3
  v_add_u32 v4, 12288, v4
  v_add_u32 v5, 12288, v5
  v_mfma_f32_32x32x16_bf16 v[176:191], v[36:39], v[220:223], v[176:191]
  v_fma_f32 v163, v163, v248, -4.0
  v_fma_f32 v164, v164, v248, -4.0
  v_fma_f32 v165, v165, v248, -4.0
  v_fma_f32 v166, v166, v248, -4.0
  v_fma_f32 v167, v167, v248, -4.0
  s_waitcnt lgkmcnt(3)
  v_mfma_f32_32x32x16_bf16 v[176:191], v[40:43], v[224:227], v[176:191]
  v_fma_f32 v168, v168, v248, -4.0
  v_fma_f32 v169, v169, v248, -4.0
  v_fma_f32 v170, v170, v248, -4.0
  v_fma_f32 v171, v171, v248, -4.0
  v_fma_f32 v172, v172, v248, -4.0
  v_fma_f32 v173, v173, v248, -4.0
  v_mfma_f32_32x32x16_bf16 v[176:191], v[44:47], v[228:231], v[176:191]
  v_fma_f32 v174, v174, v248, -4.0
  v_fma_f32 v175, v175, v248, -4.0
  v_exp_f32 v160, v160
  v_exp_f32 v161, v161
  v_exp_f32 v162, v162
  v_mfma_f32_32x32x16_bf16 v[176:191], v[48:51], v[232:235], v[176:191]
  v_exp_f32 v163, v163
  v_exp_f32 v164, v164
  v_exp_f32 v165, v165
  v_exp_f32 v166, v166
  v_exp_f32 v167, v167
  s_waitcnt lgkmcnt(0)
  v_mfma_f32_32x32x16_bf16 v[176:191], v[52:55], v[236:239], v[176:191]
  v_exp_f32 v168, v168
  v_exp_f32 v169, v169
  v_exp_f32 v170, v170
  v_exp_f32 v171, v171
  v_exp_f32 v172, v172
  v_mfma_f32_32x32x16_bf16 v[176:191], v[56:59], v[240:243], v[176:191]
  v_exp_f32 v173, v173
  v_exp_f32 v174, v174
  v_exp_f32 v175, v175
  v_cvt_pk_bf16_f32 v208, v160, v161
  v_cvt_pk_bf16_f32 v209, v162, v163
  v_mfma_f32_32x32x16_bf16 v[176:191], v[60:63], v[244:247], v[176:191]
  v_cvt_pk_bf16_f32 v210, v164, v165
  v_cvt_pk_bf16_f32 v211, v166, v167
  v_cvt_pk_bf16_f32 v212, v168, v169
  v_cvt_pk_bf16_f32 v213, v170, v171
  v_cvt_pk_bf16_f32 v214, v172, v173
  v_cvt_pk_bf16_f32 v215, v174, v175
  ds_write_b128 v14, v[208:211] offset:0
  ds_write_b128 v14, v[212:215] offset:1024
  v_add_u32 v14, 12288, v14
  s_cmp_lg_u32 s24, 0
  s_cbranch_scc1 L_npb
  s_mov_b32 s63, 0
  v_and_b32 v250, 7, v1
  v_lshlrev_b32 v250, 2, v250
  v_and_b32 v251, 8, v1
  v_lshl_add_u32 v250, v251, 5, v250
L_poll_B:
  s_mov_b32 exec_lo, 0xffff
  s_mov_b32 exec_hi, 0
  global_load_dword v10, v250, s[26:27] offset:128 sc1
  s_mov_b64 exec, -1
  s_waitcnt vmcnt(0)
  v_cmp_eq_u32 vcc, s54, v10
  s_nop 1
  s_and_b32 s60, vcc_lo, 0xffff
  s_lshr_b32 s57, s60, 8
  s_or_b32 s60, s60, s57
  s_and_b32 s60, s60, 0xff
  s_cmp_eq_u32 s60, 0xff
  s_cbranch_scc1 L_polld_B
  s_add_u32 s63, s63, 1
  s_cmp_lt_u32 s63, 0x80000
  s_cbranch_scc1 L_poll_B
L_polld_B:
L_npb:
  s_waitcnt lgkmcnt(0)
  s_barrier
  ds_read_b32 v249, v6 offset:896
  v_lshrrev_b32 v2, 5, v1
  v_lshlrev_b32 v2, 3, v2
  v_add_u32 v2, 137216, v2
  ds_read2_b64 v[216:219], v2 offset0:0 offset1:2
  ds_read2_b64 v[220:223], v2 offset0:4 offset1:6
  ds_read2_b64 v[224:227], v2 offset0:8 offset1:10
  ds_read2_b64 v[228:231], v2 offset0:12 offset1:14
  ds_read2_b64 v[232:235], v2 offset0:16 offset1:18
  ds_read2_b64 v[236:239], v2 offset0:20 offset1:22
  ds_read2_b64 v[240:243], v2 offset0:24 offset1:26
  s_waitcnt lgkmcnt(4)
  v_mfma_f32_32x32x16_bf16 v[160:175], v[216:219], v[64:67], 0
  ds_read2_b64 v[244:247], v2 offset0:28 offset1:30
  s_mul_i32 s59, s24, 9216
  buffer_load_dwordx4 v[112:115], v11, s[68:71], s59 offen sc1
  s_add_u32 s59, s59, 1024
  v_mfma_f32_32x32x16_bf16 v[160:175], v[220:223], v[68:71], v[160:175]
  ds_read2_b64 v[216:219], v2 offset0:32 offset1:34
  v_add_f32 v176, v176, v249
  v_add_f32 v177, v177, v249
  v_add_f32 v178, v178, v249
  v_add_f32 v179, v179, v249
  buffer_load_dwordx4 v[116:119], v11, s[68:71], s59 offen sc1
  s_add_u32 s59, s59, 1024
  buffer_load_dwordx4 v[120:123], v11, s[68:71], s59 offen sc1
  v_mfma_f32_32x32x16_bf16 v[160:175], v[224:227], v[72:75], v[160:175]
  ds_read2_b64 v[220:223], v2 offset0:36 offset1:38
  v_add_f32 v180, v180, v249
  v_add_f32 v181, v181, v249
  v_add_f32 v182, v182, v249
  v_add_f32 v183, v183, v249
  v_add_f32 v184, v184, v249
  s_add_u32 s59, s59, 1024
  buffer_load_dwordx4 v[124:127], v11, s[68:71], s59 offen sc1
  s_add_u32 s59, s59, 1024
  buffer_load_dwordx4 v[128:131], v11, s[68:71], s59 offen sc1
  s_waitcnt lgkmcnt(4)
  v_mfma_f32_32x32x16_bf16 v[160:175], v[228:231], v[76:79], v[160:175]
  ds_read2_b64 v[224:227], v2 offset0:40 offset1:42
  v_add_f32 v185, v185, v249
  v_add_f32 v186, v186, v249
  v_add_f32 v187, v187, v249
  v_add_f32 v188, v188, v249
  v_add_f32 v189, v189, v249
  s_add_u32 s59, s59, 1024
  buffer_load_dwordx4 v[132:135], v11, s[68:71], s59 offen sc1
  s_add_u32 s59, s59, 1024
  v_mfma_f32_32x32x16_bf16 v[160:175], v[232:235], v[80:83], v[160:175]
  ds_read2_b64 v[228:231], v2 offset0:44 offset1:46
  v_add_f32 v190, v190, v249
  v_add_f32 v191, v191, v249
  v_fma_f32 v176, v176, v248, -4.0
  v_fma_f32 v177, v177, v248, -4.0
  v_fma_f32 v178, v178, v248, -4.0
  buffer_load_dwordx4 v[136:139], v11, s[68:71], s59 offen sc1
  s_add_u32 s59, s59, 1024
  buffer_load_dwordx4 v[140:143], v11, s[68:71], s59 offen sc1
  s_add_u32 s59, s59, 1024
  v_mfma_f32_32x32x16_bf16 v[160:175], v[236:239], v[84:87], v[160:175]
  v_fma_f32 v179, v179, v248, -4.0
  v_fma_f32 v180, v180, v248, -4.0
  v_fma_f32 v181, v181, v248, -4.0
  v_fma_f32 v182, v182, v248, -4.0
  v_fma_f32 v183, v183, v248, -4.0
  buffer_load_dwordx4 v[144:147], v11, s[68:71], s59 offen sc1
  s_mul_i32 s58, s24, 9216
  v_add_u32 v148, s58, v11
  s_waitcnt lgkmcnt(3)
  v_mfma_f32_32x32x16_bf16 v[160:175], v[240:243], v[88:91], v[160:175]
  v_fma_f32 v184, v184, v248, -4.0
  v_fma_f32 v185, v185, v248, -4.0
  v_fma_f32 v186, v186, v248, -4.0
  v_fma_f32 v187, v187, v248, -4.0
  v_fma_f32 v188, v188, v248, -4.0
  v_fma_f32 v189, v189, v248, -4.0
  s_waitcnt vmcnt(8)
  ds_write_b128 v148, v[112:115] offset:0
  s_waitcnt vmcnt(7)
  ds_write_b128 v148, v[116:119] offset:1024
  v_mfma_f32_32x32x16_bf16 v[160:175], v[244:247], v[92:95], v[160:175]
  v_fma_f32 v190, v190, v248, -4.0
  v_fma_f32 v191, v191, v248, -4.0
  v_exp_f32 v176, v176
  v_exp_f32 v177, v177
  v_exp_f32 v178, v178
  s_waitcnt vmcnt(6)
  ds_write_b128 v148, v[120:123] offset:2048
  s_waitcnt vmcnt(5)
  v_mfma_f32_32x32x16_bf16 v[160:175], v[216:219], v[96:99], v[160:175]
  v_exp_f32 v179, v179
  v_exp_f32 v180, v180
  v_exp_f32 v181, v181
  v_exp_f32 v182, v182
  v_exp_f32 v183, v183
  ds_write_b128 v148, v[124:127] offset:3072
  s_waitcnt vmcnt(4)
  ds_write_b128 v148, v[128:131] offset:4096
  s_waitcnt vmcnt(3)
  s_waitcnt lgkmcnt(0)
  v_mfma_f32_32x32x16_bf16 v[160:175], v[220:223], v[100:103], v[160:175]
  v_exp_f32 v184, v184
  v_exp_f32 v185, v185
  v_exp_f32 v186, v186
  v_exp_f32 v187, v187
  v_exp_f32 v188, v188
  ds_write_b128 v148, v[132:135] offset:5120
  s_waitcnt vmcnt(2)
  ds_write_b128 v148, v[136:139] offset:6144
  v_mfma_f32_32x32x16_bf16 v[160:175], v[224:227], v[104:107], v[160:175]
  v_exp_f32 v189, v189
  v_exp_f32 v190, v190
  v_exp_f32 v191, v191
  v_cvt_pk_bf16_f32 v208, v176, v177
  v_cvt_pk_bf16_f32 v209, v178, v179
  s_waitcnt vmcnt(1)
  ds_write_b128 v148, v[140:143] offset:7168
  s_waitcnt vmcnt(0)
  ds_write_b128 v148, v[144:147] offset:8192
  v_mfma_f32_32x32x16_bf16 v[160:175], v[228:231], v[108:111], v[160:175]
  v_cvt_pk_bf16_f32 v210, v180, v181
  v_cvt_pk_bf16_f32 v211, v182, v183
  v_cvt_pk_bf16_f32 v212, v184, v185
  v_cvt_pk_bf16_f32 v213, v186, v187
  v_cvt_pk_bf16_f32 v214, v188, v189
  v_cvt_pk_bf16_f32 v215, v190, v191
  ds_write_b128 v14, v[208:211] offset:0
  ds_write_b128 v14, v[212:215] offset:1024
  s_waitcnt lgkmcnt(0)
  s_nop 3
  v_add_f32 v149, 0x3549539c, v160
  v_rcp_f32 v149, v149
  s_branch L_fin
L_prod_rest:
  s_add_u32 s32, s12, s25
  s_addc_u32 s33, s13, 0
  s_and_b32 s33, s33, 0xffff
  s_mov_b32 s34, 98304
  s_mov_b32 s35, 0x20000
  v_mul_u32_u24 v11, 384, v7
  v_lshrrev_b32 v12, 2, v1
  v_and_b32 v12, 4, v12
  v_xor_b32 v12, v12, v8
  v_lshl_add_u32 v227, v12, 4, v11
  s_lshl_b32 s61, s52, 10
  s_mul_i32 s52, s52, 3072
  s_lshl_b32 s57, s22, 9
  s_add_u32 s57, s57, 30408704
  s_add_u32 s26, s20, s57
  s_addc_u32 s27, s21, 0
  s_cmp_lg_u32 s24, 6
  s_cbranch_scc1 L_sy1
  v_lshlrev_b32 v232, 7, v7
  v_lshl_add_u32 v232, v8, 2, v232
  s_mov_b32 exec_lo, -1
  s_mov_b32 exec_hi, 0
  global_load_dword v230, v232, s[26:27] sc1
  s_mov_b64 exec, -1
L_sy1:
  s_add_u32 s64, s8, s25
  s_addc_u32 s65, s9, 0
  s_and_b32 s65, s65, 0xffff
  s_mov_b32 s66, 98304
  s_mov_b32 s67, 0x20000
  v_lshrrev_b32 v11, 1, v7
  v_xor_b32 v11, v11, v8
  v_lshlrev_b32 v12, 4, v11
  v_lshlrev_b32 v10, 7, v9
  v_add_u32 v3, v10, v12
  v_xor_b32 v4, 64, v3
  v_add_u32 v4, 1024, v4
  v_lshlrev_b32 v5, 2, v9
  v_add_u32 v5, 135168, v5
  v_mov_b32 v224, 0x3e898b82
  v_mov_b32 v225, 0x3e898b82
  v_mov_b32 v226, 0xffff0000
  v_add_u32 v13, 98304, v3
  v_add_u32 v14, 98304, v4
  s_waitcnt vmcnt(6)
  v_mov_b32 v216, 0
  v_mov_b32 v218, 0
  v_lshlrev_b32 v208, 16, v16
  v_lshlrev_b32 v210, 16, v17
  v_lshlrev_b32 v212, 16, v18
  v_lshlrev_b32 v214, 16, v19
  v_and_b32 v209, v226, v16
  v_and_b32 v211, v226, v17
  v_and_b32 v213, v226, v18
  v_and_b32 v215, v226, v19
  v_pk_mul_f32 v[208:209], v[208:209], v[224:225]
  v_pk_mul_f32 v[210:211], v[210:211], v[224:225]
  v_pk_mul_f32 v[212:213], v[212:213], v[224:225]
  v_pk_mul_f32 v[214:215], v[214:215], v[224:225]
  v_cvt_pk_bf16_f32 v16, v208, v209
  v_cvt_pk_bf16_f32 v17, v210, v211
  v_cvt_pk_bf16_f32 v18, v212, v213
  v_cvt_pk_bf16_f32 v19, v214, v215
  v_dot2c_f32_bf16 v216, v16, v16
  v_dot2c_f32_bf16 v218, v17, v17
  v_dot2c_f32_bf16 v216, v18, v18
  v_dot2c_f32_bf16 v218, v19, v19
  ds_write_b128 v13, v[16:19] offset:0
  v_lshlrev_b32 v208, 16, v20
  v_lshlrev_b32 v210, 16, v21
  v_lshlrev_b32 v212, 16, v22
  v_lshlrev_b32 v214, 16, v23
  v_and_b32 v209, v226, v20
  v_and_b32 v211, v226, v21
  v_and_b32 v213, v226, v22
  v_and_b32 v215, v226, v23
  v_pk_mul_f32 v[208:209], v[208:209], v[224:225]
  v_pk_mul_f32 v[210:211], v[210:211], v[224:225]
  v_pk_mul_f32 v[212:213], v[212:213], v[224:225]
  v_pk_mul_f32 v[214:215], v[214:215], v[224:225]
  v_cvt_pk_bf16_f32 v20, v208, v209
  v_cvt_pk_bf16_f32 v21, v210, v211
  v_cvt_pk_bf16_f32 v22, v212, v213
  v_cvt_pk_bf16_f32 v23, v214, v215
  v_dot2c_f32_bf16 v216, v20, v20
  v_dot2c_f32_bf16 v218, v21, v21
  v_dot2c_f32_bf16 v216, v22, v22
  v_dot2c_f32_bf16 v218, v23, v23
  ds_write_b128 v13, v[20:23] offset:4096
  v_lshlrev_b32 v208, 16, v24
  v_lshlrev_b32 v210, 16, v25
  v_lshlrev_b32 v212, 16, v26
  v_lshlrev_b32 v214, 16, v27
  v_and_b32 v209, v226, v24
  v_and_b32 v211, v226, v25
  v_and_b32 v213, v226, v26
  v_and_b32 v215, v226, v27
  v_pk_mul_f32 v[208:209], v[208:209], v[224:225]
  v_pk_mul_f32 v[210:211], v[210:211], v[224:225]
  v_pk_mul_f32 v[212:213], v[212:213], v[224:225]
  v_pk_mul_f32 v[214:215], v[214:215], v[224:225]
  v_cvt_pk_bf16_f32 v24, v208, v209
  v_cvt_pk_bf16_f32 v25, v210, v211
  v_cvt_pk_bf16_f32 v26, v212, v213
  v_cvt_pk_bf16_f32 v27, v214, v215
  v_dot2c_f32_bf16 v216, v24, v24
  v_dot2c_f32_bf16 v218, v25, v25
  v_dot2c_f32_bf16 v216, v26, v26
  v_dot2c_f32_bf16 v218, v27, v27
  ds_write_b128 v13, v[24:27] offset:8192
  s_nop 1
  v_add_f32 v216, v216, v218
  v_mov_b32 v217, 0
  v_mov_b32 v219, 0
  v_lshlrev_b32 v208, 16, v28
  v_lshlrev_b32 v210, 16, v29
  v_lshlrev_b32 v212, 16, v30
  v_lshlrev_b32 v214, 16, v31
  v_and_b32 v209, v226, v28
  v_and_b32 v211, v226, v29
  v_and_b32 v213, v226, v30
  v_and_b32 v215, v226, v31
  v_pk_mul_f32 v[208:209], v[208:209], v[224:225]
  v_pk_mul_f32 v[210:211], v[210:211], v[224:225]
  v_pk_mul_f32 v[212:213], v[212:213], v[224:225]
  v_pk_mul_f32 v[214:215], v[214:215], v[224:225]
  v_cvt_pk_bf16_f32 v28, v208, v209
  v_cvt_pk_bf16_f32 v29, v210, v211
  v_cvt_pk_bf16_f32 v30, v212, v213
  v_cvt_pk_bf16_f32 v31, v214, v215
  v_dot2c_f32_bf16 v217, v28, v28
  v_dot2c_f32_bf16 v219, v29, v29
  v_dot2c_f32_bf16 v217, v30, v30
  v_dot2c_f32_bf16 v219, v31, v31
  ds_write_b128 v14, v[28:31] offset:0
  v_lshlrev_b32 v208, 16, v32
  v_lshlrev_b32 v210, 16, v33
  v_lshlrev_b32 v212, 16, v34
  v_lshlrev_b32 v214, 16, v35
  v_and_b32 v209, v226, v32
  v_and_b32 v211, v226, v33
  v_and_b32 v213, v226, v34
  v_and_b32 v215, v226, v35
  v_pk_mul_f32 v[208:209], v[208:209], v[224:225]
  v_pk_mul_f32 v[210:211], v[210:211], v[224:225]
  v_pk_mul_f32 v[212:213], v[212:213], v[224:225]
  v_pk_mul_f32 v[214:215], v[214:215], v[224:225]
  v_cvt_pk_bf16_f32 v32, v208, v209
  v_cvt_pk_bf16_f32 v33, v210, v211
  v_cvt_pk_bf16_f32 v34, v212, v213
  v_cvt_pk_bf16_f32 v35, v214, v215
  v_dot2c_f32_bf16 v217, v32, v32
  v_dot2c_f32_bf16 v219, v33, v33
  v_dot2c_f32_bf16 v217, v34, v34
  v_dot2c_f32_bf16 v219, v35, v35
  ds_write_b128 v14, v[32:35] offset:4096
  v_lshlrev_b32 v208, 16, v36
  v_lshlrev_b32 v210, 16, v37
  v_lshlrev_b32 v212, 16, v38
  v_lshlrev_b32 v214, 16, v39
  v_and_b32 v209, v226, v36
  v_and_b32 v211, v226, v37
  v_and_b32 v213, v226, v38
  v_and_b32 v215, v226, v39
  v_pk_mul_f32 v[208:209], v[208:209], v[224:225]
  v_pk_mul_f32 v[210:211], v[210:211], v[224:225]
  v_pk_mul_f32 v[212:213], v[212:213], v[224:225]
  v_pk_mul_f32 v[214:215], v[214:215], v[224:225]
  v_cvt_pk_bf16_f32 v36, v208, v209
  v_cvt_pk_bf16_f32 v37, v210, v211
  v_cvt_pk_bf16_f32 v38, v212, v213
  v_cvt_pk_bf16_f32 v39, v214, v215
  v_dot2c_f32_bf16 v217, v36, v36
  v_dot2c_f32_bf16 v219, v37, v37
  v_dot2c_f32_bf16 v217, v38, v38
  v_dot2c_f32_bf16 v219, v39, v39
  ds_write_b128 v14, v[36:39] offset:8192
  s_nop 1
  v_add_f32 v217, v217, v219
  v_add_f32_dpp v216, v216, v216 quad_perm:[1,0,3,2] row_mask:0xf bank_mask:0xf
  s_nop 0
  v_add_f32_dpp v217, v217, v217 quad_perm:[1,0,3,2] row_mask:0xf bank_mask:0xf
  v_add_f32_dpp v216, v216, v216 quad_perm:[2,3,0,1] row_mask:0xf bank_mask:0xf
  s_nop 0
  v_add_f32_dpp v217, v217, v217 quad_perm:[2,3,0,1] row_mask:0xf bank_mask:0xf
  v_add_f32_dpp v216, v216, v216 row_half_mirror row_mask:0xf bank_mask:0xf
  s_nop 0
  v_add_f32_dpp v217, v217, v217 row_half_mirror row_mask:0xf bank_mask:0xf
  v_cvt_pk_bf16_f32 v216, 0, v216
  v_cvt_pk_bf16_f32 v217, 0, v217
  v_mul_f32 v216, -0.5, v216
  v_mul_f32 v217, -0.5, v217
  ds_write_b32 v5, v216 offset:0
  ds_write_b32 v5, v217 offset:32
  s_waitcnt lgkmcnt(0)
  s_mov_b32 s58, 24576
  buffer_load_dwordx4 v[64:67], v2, s[28:31], s58 offen offset:0 nt
  buffer_load_dwordx4 v[68:71], v2, s[28:31], s58 offen offset:128 nt
  buffer_load_dwordx4 v[72:75], v2, s[28:31], s58 offen offset:256 nt
  buffer_load_dwordx4 v[76:79], v2, s[28:31], s58 offen offset:3072 nt
  buffer_load_dwordx4 v[80:83], v2, s[28:31], s58 offen offset:3200 nt
  buffer_load_dwordx4 v[84:87], v2, s[28:31], s58 offen offset:3328 nt
  s_add_u32 m0, s61, 0
  s_add_u32 s58, s52, 0
  buffer_load_dwordx4 v227, s[32:35], s58 offen nt lds
  s_add_u32 m0, s61, 4096
  s_add_u32 s58, s52, 128
  buffer_load_dwordx4 v227, s[32:35], s58 offen nt lds
  s_add_u32 m0, s61, 8192
  s_add_u32 s58, s52, 256
  buffer_load_dwordx4 v227, s[32:35], s58 offen nt lds
  s_add_u32 m0, s61, 1024
  s_add_u32 s58, s52, 3072
  buffer_load_dwordx4 v227, s[32:35], s58 offen nt lds
  s_add_u32 m0, s61, 5120
  s_add_u32 s58, s52, 3200
  buffer_load_dwordx4 v227, s[32:35], s58 offen nt lds
  s_add_u32 m0, s61, 9216
  s_add_u32 s58, s52, 3328
  buffer_load_dwordx4 v227, s[32:35], s58 offen nt lds
  s_mov_b32 s58, 36864
  buffer_load_dwordx4 v[88:91], v2, s[28:31], s58 offen offset:0 nt
  buffer_load_dwordx4 v[92:95], v2, s[28:31], s58 offen offset:128 nt
  buffer_load_dwordx4 v[96:99], v2, s[28:31], s58 offen offset:256 nt
  buffer_load_dwordx4 v[100:103], v2, s[28:31], s58 offen offset:3072 nt
  buffer_load_dwordx4 v[104:107], v2, s[28:31], s58 offen offset:3200 nt
  buffer_load_dwordx4 v[108:111], v2, s[28:31], s58 offen offset:3328 nt
  s_waitcnt vmcnt(18)
  v_mov_b32 v216, 0
  v_mov_b32 v218, 0
  v_lshlrev_b32 v208, 16, v40
  v_lshlrev_b32 v210, 16, v41
  v_lshlrev_b32 v212, 16, v42
  v_lshlrev_b32 v214, 16, v43
  v_and_b32 v209, v226, v40
  v_and_b32 v211, v226, v41
  v_and_b32 v213, v226, v42
  v_and_b32 v215, v226, v43
  v_pk_mul_f32 v[208:209], v[208:209], v[224:225]
  v_pk_mul_f32 v[210:211], v[210:211], v[224:225]
  v_pk_mul_f32 v[212:213], v[212:213], v[224:225]
  v_pk_mul_f32 v[214:215], v[214:215], v[224:225]
  v_cvt_pk_bf16_f32 v40, v208, v209
  v_cvt_pk_bf16_f32 v41, v210, v211
  v_cvt_pk_bf16_f32 v42, v212, v213
  v_cvt_pk_bf16_f32 v43, v214, v215
  v_dot2c_f32_bf16 v216, v40, v40
  v_dot2c_f32_bf16 v218, v41, v41
  v_dot2c_f32_bf16 v216, v42, v42
  v_dot2c_f32_bf16 v218, v43, v43
  ds_write_b128 v13, v[40:43] offset:12288
  v_lshlrev_b32 v208, 16, v44
  v_lshlrev_b32 v210, 16, v45
  v_lshlrev_b32 v212, 16, v46
  v_lshlrev_b32 v214, 16, v47
  v_and_b32 v209, v226, v44
  v_and_b32 v211, v226, v45
  v_and_b32 v213, v226, v46
  v_and_b32 v215, v226, v47
  v_pk_mul_f32 v[208:209], v[208:209], v[224:225]
  v_pk_mul_f32 v[210:211], v[210:211], v[224:225]
  v_pk_mul_f32 v[212:213], v[212:213], v[224:225]
  v_pk_mul_f32 v[214:215], v[214:215], v[224:225]
  v_cvt_pk_bf16_f32 v44, v208, v209
  v_cvt_pk_bf16_f32 v45, v210, v211
  v_cvt_pk_bf16_f32 v46, v212, v213
  v_cvt_pk_bf16_f32 v47, v214, v215
  v_dot2c_f32_bf16 v216, v44, v44
  v_dot2c_f32_bf16 v218, v45, v45
  v_dot2c_f32_bf16 v216, v46, v46
  v_dot2c_f32_bf16 v218, v47, v47
  ds_write_b128 v13, v[44:47] offset:16384
  v_lshlrev_b32 v208, 16, v48
  v_lshlrev_b32 v210, 16, v49
  v_lshlrev_b32 v212, 16, v50
  v_lshlrev_b32 v214, 16, v51
  v_and_b32 v209, v226, v48
  v_and_b32 v211, v226, v49
  v_and_b32 v213, v226, v50
  v_and_b32 v215, v226, v51
  v_pk_mul_f32 v[208:209], v[208:209], v[224:225]
  v_pk_mul_f32 v[210:211], v[210:211], v[224:225]
  v_pk_mul_f32 v[212:213], v[212:213], v[224:225]
  v_pk_mul_f32 v[214:215], v[214:215], v[224:225]
  v_cvt_pk_bf16_f32 v48, v208, v209
  v_cvt_pk_bf16_f32 v49, v210, v211
  v_cvt_pk_bf16_f32 v50, v212, v213
  v_cvt_pk_bf16_f32 v51, v214, v215
  v_dot2c_f32_bf16 v216, v48, v48
  v_dot2c_f32_bf16 v218, v49, v49
  v_dot2c_f32_bf16 v216, v50, v50
  v_dot2c_f32_bf16 v218, v51, v51
  ds_write_b128 v13, v[48:51] offset:20480
  s_nop 1
  v_add_f32 v216, v216, v218
  v_mov_b32 v217, 0
  v_mov_b32 v219, 0
  v_lshlrev_b32 v208, 16, v52
  v_lshlrev_b32 v210, 16, v53
  v_lshlrev_b32 v212, 16, v54
  v_lshlrev_b32 v214, 16, v55
  v_and_b32 v209, v226, v52
  v_and_b32 v211, v226, v53
  v_and_b32 v213, v226, v54
  v_and_b32 v215, v226, v55
  v_pk_mul_f32 v[208:209], v[208:209], v[224:225]
  v_pk_mul_f32 v[210:211], v[210:211], v[224:225]
  v_pk_mul_f32 v[212:213], v[212:213], v[224:225]
  v_pk_mul_f32 v[214:215], v[214:215], v[224:225]
  v_cvt_pk_bf16_f32 v52, v208, v209
  v_cvt_pk_bf16_f32 v53, v210, v211
  v_cvt_pk_bf16_f32 v54, v212, v213
  v_cvt_pk_bf16_f32 v55, v214, v215
  v_dot2c_f32_bf16 v217, v52, v52
  v_dot2c_f32_bf16 v219, v53, v53
  v_dot2c_f32_bf16 v217, v54, v54
  v_dot2c_f32_bf16 v219, v55, v55
  ds_write_b128 v14, v[52:55] offset:12288
  v_lshlrev_b32 v208, 16, v56
  v_lshlrev_b32 v210, 16, v57
  v_lshlrev_b32 v212, 16, v58
  v_lshlrev_b32 v214, 16, v59
  v_and_b32 v209, v226, v56
  v_and_b32 v211, v226, v57
  v_and_b32 v213, v226, v58
  v_and_b32 v215, v226, v59
  v_pk_mul_f32 v[208:209], v[208:209], v[224:225]
  v_pk_mul_f32 v[210:211], v[210:211], v[224:225]
  v_pk_mul_f32 v[212:213], v[212:213], v[224:225]
  v_pk_mul_f32 v[214:215], v[214:215], v[224:225]
  v_cvt_pk_bf16_f32 v56, v208, v209
  v_cvt_pk_bf16_f32 v57, v210, v211
  v_cvt_pk_bf16_f32 v58, v212, v213
  v_cvt_pk_bf16_f32 v59, v214, v215
  v_dot2c_f32_bf16 v217, v56, v56
  v_dot2c_f32_bf16 v219, v57, v57
  v_dot2c_f32_bf16 v217, v58, v58
  v_dot2c_f32_bf16 v219, v59, v59
  ds_write_b128 v14, v[56:59] offset:16384
  v_lshlrev_b32 v208, 16, v60
  v_lshlrev_b32 v210, 16, v61
  v_lshlrev_b32 v212, 16, v62
  v_lshlrev_b32 v214, 16, v63
  v_and_b32 v209, v226, v60
  v_and_b32 v211, v226, v61
  v_and_b32 v213, v226, v62
  v_and_b32 v215, v226, v63
  v_pk_mul_f32 v[208:209], v[208:209], v[224:225]
  v_pk_mul_f32 v[210:211], v[210:211], v[224:225]
  v_pk_mul_f32 v[212:213], v[212:213], v[224:225]
  v_pk_mul_f32 v[214:215], v[214:215], v[224:225]
  v_cvt_pk_bf16_f32 v60, v208, v209
  v_cvt_pk_bf16_f32 v61, v210, v211
  v_cvt_pk_bf16_f32 v62, v212, v213
  v_cvt_pk_bf16_f32 v63, v214, v215
  v_dot2c_f32_bf16 v217, v60, v60
  v_dot2c_f32_bf16 v219, v61, v61
  v_dot2c_f32_bf16 v217, v62, v62
  v_dot2c_f32_bf16 v219, v63, v63
  ds_write_b128 v14, v[60:63] offset:20480
  s_nop 1
  v_add_f32 v217, v217, v219
  v_add_f32_dpp v216, v216, v216 quad_perm:[1,0,3,2] row_mask:0xf bank_mask:0xf
  s_nop 0
  v_add_f32_dpp v217, v217, v217 quad_perm:[1,0,3,2] row_mask:0xf bank_mask:0xf
  v_add_f32_dpp v216, v216, v216 quad_perm:[2,3,0,1] row_mask:0xf bank_mask:0xf
  s_nop 0
  v_add_f32_dpp v217, v217, v217 quad_perm:[2,3,0,1] row_mask:0xf bank_mask:0xf
  v_add_f32_dpp v216, v216, v216 row_half_mirror row_mask:0xf bank_mask:0xf
  s_nop 0
  v_add_f32_dpp v217, v217, v217 row_half_mirror row_mask:0xf bank_mask:0xf
  v_cvt_pk_bf16_f32 v216, 0, v216
  v_cvt_pk_bf16_f32 v217, 0, v217
  v_mul_f32 v216, -0.5, v216
  v_mul_f32 v217, -0.5, v217
  ds_write_b32 v5, v216 offset:128
  ds_write_b32 v5, v217 offset:160
  s_waitcnt lgkmcnt(0)
  s_add_u32 m0, s61, 12288
  s_add_u32 s58, s52, 12288
  buffer_load_dwordx4 v227, s[32:35], s58 offen nt lds
  s_add_u32 m0, s61, 16384
  s_add_u32 s58, s52, 12416
  buffer_load_dwordx4 v227, s[32:35], s58 offen nt lds
  s_add_u32 m0, s61, 20480
  s_add_u32 s58, s52, 12544
  buffer_load_dwordx4 v227, s[32:35], s58 offen nt lds
  s_add_u32 m0, s61, 13312
  s_add_u32 s58, s52, 15360
  buffer_load_dwordx4 v227, s[32:35], s58 offen nt lds
  s_add_u32 m0, s61, 17408
  s_add_u32 s58, s52, 15488
  buffer_load_dwordx4 v227, s[32:35], s58 offen nt lds
  s_add_u32 m0, s61, 21504
  s_add_u32 s58, s52, 15616
  buffer_load_dwordx4 v227, s[32:35], s58 offen nt lds
  s_mov_b32 s58, 49152
  buffer_load_dwordx4 v[112:115], v2, s[28:31], s58 offen offset:0 nt
  buffer_load_dwordx4 v[116:119], v2, s[28:31], s58 offen offset:128 nt
  buffer_load_dwordx4 v[120:123], v2, s[28:31], s58 offen offset:256 nt
  buffer_load_dwordx4 v[124:127], v2, s[28:31], s58 offen offset:3072 nt
  buffer_load_dwordx4 v[128:131], v2, s[28:31], s58 offen offset:3200 nt
  buffer_load_dwordx4 v[132:135], v2, s[28:31], s58 offen offset:3328 nt
  s_barrier
  s_waitcnt vmcnt(24)
  v_mov_b32 v216, 0
  v_mov_b32 v218, 0
  v_lshlrev_b32 v208, 16, v64
  v_lshlrev_b32 v210, 16, v65
  v_lshlrev_b32 v212, 16, v66
  v_lshlrev_b32 v214, 16, v67
  v_and_b32 v209, v226, v64
  v_and_b32 v211, v226, v65
  v_and_b32 v213, v226, v66
  v_and_b32 v215, v226, v67
  v_pk_mul_f32 v[208:209], v[208:209], v[224:225]
  v_pk_mul_f32 v[210:211], v[210:211], v[224:225]
  v_pk_mul_f32 v[212:213], v[212:213], v[224:225]
  v_pk_mul_f32 v[214:215], v[214:215], v[224:225]
  v_cvt_pk_bf16_f32 v64, v208, v209
  v_cvt_pk_bf16_f32 v65, v210, v211
  v_cvt_pk_bf16_f32 v66, v212, v213
  v_cvt_pk_bf16_f32 v67, v214, v215
  v_dot2c_f32_bf16 v216, v64, v64
  v_dot2c_f32_bf16 v218, v65, v65
  v_dot2c_f32_bf16 v216, v66, v66
  v_dot2c_f32_bf16 v218, v67, v67
  ds_write_b128 v13, v[64:67] offset:24576
  v_lshlrev_b32 v208, 16, v68
  v_lshlrev_b32 v210, 16, v69
  v_lshlrev_b32 v212, 16, v70
  v_lshlrev_b32 v214, 16, v71
  v_and_b32 v209, v226, v68
  v_and_b32 v211, v226, v69
  v_and_b32 v213, v226, v70
  v_and_b32 v215, v226, v71
  v_pk_mul_f32 v[208:209], v[208:209], v[224:225]
  v_pk_mul_f32 v[210:211], v[210:211], v[224:225]
  v_pk_mul_f32 v[212:213], v[212:213], v[224:225]
  v_pk_mul_f32 v[214:215], v[214:215], v[224:225]
  v_cvt_pk_bf16_f32 v68, v208, v209
  v_cvt_pk_bf16_f32 v69, v210, v211
  v_cvt_pk_bf16_f32 v70, v212, v213
  v_cvt_pk_bf16_f32 v71, v214, v215
  v_dot2c_f32_bf16 v216, v68, v68
  v_dot2c_f32_bf16 v218, v69, v69
  v_dot2c_f32_bf16 v216, v70, v70
  v_dot2c_f32_bf16 v218, v71, v71
  ds_write_b128 v13, v[68:71] offset:28672
  v_lshlrev_b32 v208, 16, v72
  v_lshlrev_b32 v210, 16, v73
  v_lshlrev_b32 v212, 16, v74
  v_lshlrev_b32 v214, 16, v75
  v_and_b32 v209, v226, v72
  v_and_b32 v211, v226, v73
  v_and_b32 v213, v226, v74
  v_and_b32 v215, v226, v75
  v_pk_mul_f32 v[208:209], v[208:209], v[224:225]
  v_pk_mul_f32 v[210:211], v[210:211], v[224:225]
  v_pk_mul_f32 v[212:213], v[212:213], v[224:225]
  v_pk_mul_f32 v[214:215], v[214:215], v[224:225]
  v_cvt_pk_bf16_f32 v72, v208, v209
  v_cvt_pk_bf16_f32 v73, v210, v211
  v_cvt_pk_bf16_f32 v74, v212, v213
  v_cvt_pk_bf16_f32 v75, v214, v215
  v_dot2c_f32_bf16 v216, v72, v72
  v_dot2c_f32_bf16 v218, v73, v73
  v_dot2c_f32_bf16 v216, v74, v74
  v_dot2c_f32_bf16 v218, v75, v75
  ds_write_b128 v13, v[72:75] offset:32768
  s_nop 1
  v_add_f32 v216, v216, v218
  v_mov_b32 v217, 0
  v_mov_b32 v219, 0
  v_lshlrev_b32 v208, 16, v76
  v_lshlrev_b32 v210, 16, v77
  v_lshlrev_b32 v212, 16, v78
  v_lshlrev_b32 v214, 16, v79
  v_and_b32 v209, v226, v76
  v_and_b32 v211, v226, v77
  v_and_b32 v213, v226, v78
  v_and_b32 v215, v226, v79
  v_pk_mul_f32 v[208:209], v[208:209], v[224:225]
  v_pk_mul_f32 v[210:211], v[210:211], v[224:225]
  v_pk_mul_f32 v[212:213], v[212:213], v[224:225]
  v_pk_mul_f32 v[214:215], v[214:215], v[224:225]
  v_cvt_pk_bf16_f32 v76, v208, v209
  v_cvt_pk_bf16_f32 v77, v210, v211
  v_cvt_pk_bf16_f32 v78, v212, v213
  v_cvt_pk_bf16_f32 v79, v214, v215
  v_dot2c_f32_bf16 v217, v76, v76
  v_dot2c_f32_bf16 v219, v77, v77
  v_dot2c_f32_bf16 v217, v78, v78
  v_dot2c_f32_bf16 v219, v79, v79
  ds_write_b128 v14, v[76:79] offset:24576
  v_lshlrev_b32 v208, 16, v80
  v_lshlrev_b32 v210, 16, v81
  v_lshlrev_b32 v212, 16, v82
  v_lshlrev_b32 v214, 16, v83
  v_and_b32 v209, v226, v80
  v_and_b32 v211, v226, v81
  v_and_b32 v213, v226, v82
  v_and_b32 v215, v226, v83
  v_pk_mul_f32 v[208:209], v[208:209], v[224:225]
  v_pk_mul_f32 v[210:211], v[210:211], v[224:225]
  v_pk_mul_f32 v[212:213], v[212:213], v[224:225]
  v_pk_mul_f32 v[214:215], v[214:215], v[224:225]
  v_cvt_pk_bf16_f32 v80, v208, v209
  v_cvt_pk_bf16_f32 v81, v210, v211
  v_cvt_pk_bf16_f32 v82, v212, v213
  v_cvt_pk_bf16_f32 v83, v214, v215
  v_dot2c_f32_bf16 v217, v80, v80
  v_dot2c_f32_bf16 v219, v81, v81
  v_dot2c_f32_bf16 v217, v82, v82
  v_dot2c_f32_bf16 v219, v83, v83
  ds_write_b128 v14, v[80:83] offset:28672
  v_lshlrev_b32 v208, 16, v84
  v_lshlrev_b32 v210, 16, v85
  v_lshlrev_b32 v212, 16, v86
  v_lshlrev_b32 v214, 16, v87
  v_and_b32 v209, v226, v84
  v_and_b32 v211, v226, v85
  v_and_b32 v213, v226, v86
  v_and_b32 v215, v226, v87
  v_pk_mul_f32 v[208:209], v[208:209], v[224:225]
  v_pk_mul_f32 v[210:211], v[210:211], v[224:225]
  v_pk_mul_f32 v[212:213], v[212:213], v[224:225]
  v_pk_mul_f32 v[214:215], v[214:215], v[224:225]
  v_cvt_pk_bf16_f32 v84, v208, v209
  v_cvt_pk_bf16_f32 v85, v210, v211
  v_cvt_pk_bf16_f32 v86, v212, v213
  v_cvt_pk_bf16_f32 v87, v214, v215
  v_dot2c_f32_bf16 v217, v84, v84
  v_dot2c_f32_bf16 v219, v85, v85
  v_dot2c_f32_bf16 v217, v86, v86
  v_dot2c_f32_bf16 v219, v87, v87
  ds_write_b128 v14, v[84:87] offset:32768
  s_nop 1
  v_add_f32 v217, v217, v219
  v_add_f32_dpp v216, v216, v216 quad_perm:[1,0,3,2] row_mask:0xf bank_mask:0xf
  s_nop 0
  v_add_f32_dpp v217, v217, v217 quad_perm:[1,0,3,2] row_mask:0xf bank_mask:0xf
  v_add_f32_dpp v216, v216, v216 quad_perm:[2,3,0,1] row_mask:0xf bank_mask:0xf
  s_nop 0
  v_add_f32_dpp v217, v217, v217 quad_perm:[2,3,0,1] row_mask:0xf bank_mask:0xf
  v_add_f32_dpp v216, v216, v216 row_half_mirror row_mask:0xf bank_mask:0xf
  s_nop 0
  v_add_f32_dpp v217, v217, v217 row_half_mirror row_mask:0xf bank_mask:0xf
  v_cvt_pk_bf16_f32 v216, 0, v216
  v_cvt_pk_bf16_f32 v217, 0, v217
  v_mul_f32 v216, -0.5, v216
  v_mul_f32 v217, -0.5, v217
  ds_write_b32 v5, v216 offset:256
  ds_write_b32 v5, v217 offset:288
  s_waitcnt lgkmcnt(0)
  s_barrier
  s_waitcnt vmcnt(18)
  s_barrier
  s_cmp_lg_u32 s24, 6
  s_cbranch_scc1 L_sy3
  v_subrev_u32 v232, 1, v230
  v_mov_b32 v233, 1
  v_lshlrev_b32 v233, v232, v233
  v_mov_b32 v234, 0
  v_mov_b32 v235, 0
  v_cmp_gt_u32 vcc, 32, v232
  s_nop 1
  s_mov_b32 vcc_hi, 0
  v_cndmask_b32 v234, 0, v233, vcc
  v_subrev_u32 v232, 32, v232
  v_cmp_gt_u32 vcc, 32, v232
  s_nop 1
  s_mov_b32 vcc_hi, 0
  v_cndmask_b32 v235, 0, v233, vcc
  v_or_b32_dpp v234, v234, v234 row_shr:1 row_mask:0xf bank_mask:0xf
  s_nop 1
  v_or_b32_dpp v234, v234, v234 row_shr:2 row_mask:0xf bank_mask:0xf
  s_nop 1
  v_or_b32_dpp v234, v234, v234 row_shr:4 row_mask:0xf bank_mask:0xf
  s_nop 1
  v_or_b32_dpp v234, v234, v234 row_shr:8 row_mask:0xf bank_mask:0xf
  v_or_b32_dpp v235, v235, v235 row_shr:1 row_mask:0xf bank_mask:0xf
  s_nop 1
  v_or_b32_dpp v235, v235, v235 row_shr:2 row_mask:0xf bank_mask:0xf
  s_nop 1
  v_or_b32_dpp v235, v235, v235 row_shr:4 row_mask:0xf bank_mask:0xf
  s_nop 1
  v_or_b32_dpp v235, v235, v235 row_shr:8 row_mask:0xf bank_mask:0xf
  v_readlane_b32 s74, v234, 15
  v_readlane_b32 s57, v234, 31
  v_readlane_b32 s75, v235, 15
  v_readlane_b32 s58, v235, 31
  s_or_b32 s74, s74, s57
  s_or_b32 s75, s75, s58
  s_ff0_i32_b64 s53, s[74:75]
  s_add_u32 s53, s53, 1
  s_getreg_b32 s73, hwreg(HW_REG_XCC_ID, 0, 4)
  s_and_b32 s73, s73, 7
  s_lshl_b32 s73, s73, 2
  s_lshl_b32 s57, 1, s73
  v_mov_b32 v234, s53
  v_mov_b32 v235, 0
  s_lshl_b32 s58, s22, 3
  v_mov_b32 v236, s58
  v_mov_b32 v237, s57
  s_mov_b32 exec_lo, 1
  s_mov_b32 exec_hi, 0
  global_atomic_cmpswap v232, v236, v[234:235], s[18:19] sc0 sc1
  global_atomic_add v236, v237, s[18:19] offset:4 sc1
  s_mov_b64 exec, -1
L_sy3:
  s_add_u32 m0, s61, 24576
  s_add_u32 s58, s52, 24576
  buffer_load_dwordx4 v227, s[32:35], s58 offen nt lds
  s_add_u32 m0, s61, 28672
  s_add_u32 s58, s52, 24704
  buffer_load_dwordx4 v227, s[32:35], s58 offen nt lds
  s_add_u32 m0, s61, 32768
  s_add_u32 s58, s52, 24832
  buffer_load_dwordx4 v227, s[32:35], s58 offen nt lds
  s_add_u32 m0, s61, 25600
  s_add_u32 s58, s52, 27648
  buffer_load_dwordx4 v227, s[32:35], s58 offen nt lds
  s_add_u32 m0, s61, 29696
  s_add_u32 s58, s52, 27776
  buffer_load_dwordx4 v227, s[32:35], s58 offen nt lds
  s_add_u32 m0, s61, 33792
  s_add_u32 s58, s52, 27904
  buffer_load_dwordx4 v227, s[32:35], s58 offen nt lds
  s_mov_b32 s58, 61440
  buffer_load_dwordx4 v[136:139], v2, s[28:31], s58 offen offset:0 nt
  buffer_load_dwordx4 v[140:143], v2, s[28:31], s58 offen offset:128 nt
  buffer_load_dwordx4 v[144:147], v2, s[28:31], s58 offen offset:256 nt
  buffer_load_dwordx4 v[148:151], v2, s[28:31], s58 offen offset:3072 nt
  buffer_load_dwordx4 v[152:155], v2, s[28:31], s58 offen offset:3200 nt
  buffer_load_dwordx4 v[156:159], v2, s[28:31], s58 offen offset:3328 nt
  s_add_u32 m0, s61, 36864
  s_add_u32 s58, s52, 36864
  buffer_load_dwordx4 v227, s[32:35], s58 offen nt lds
  s_add_u32 m0, s61, 40960
  s_add_u32 s58, s52, 36992
  buffer_load_dwordx4 v227, s[32:35], s58 offen nt lds
  s_add_u32 m0, s61, 45056
  s_add_u32 s58, s52, 37120
  buffer_load_dwordx4 v227, s[32:35], s58 offen nt lds
  s_add_u32 m0, s61, 37888
  s_add_u32 s58, s52, 39936
  buffer_load_dwordx4 v227, s[32:35], s58 offen nt lds
  s_add_u32 m0, s61, 41984
  s_add_u32 s58, s52, 40064
  buffer_load_dwordx4 v227, s[32:35], s58 offen nt lds
  s_add_u32 m0, s61, 46080
  s_add_u32 s58, s52, 40192
  buffer_load_dwordx4 v227, s[32:35], s58 offen nt lds
  s_waitcnt vmcnt(30)
  v_mov_b32 v216, 0
  v_mov_b32 v218, 0
  v_lshlrev_b32 v208, 16, v88
  v_lshlrev_b32 v210, 16, v89
  v_lshlrev_b32 v212, 16, v90
  v_lshlrev_b32 v214, 16, v91
  v_and_b32 v209, v226, v88
  v_and_b32 v211, v226, v89
  v_and_b32 v213, v226, v90
  v_and_b32 v215, v226, v91
  v_pk_mul_f32 v[208:209], v[208:209], v[224:225]
  v_pk_mul_f32 v[210:211], v[210:211], v[224:225]
  v_pk_mul_f32 v[212:213], v[212:213], v[224:225]
  v_pk_mul_f32 v[214:215], v[214:215], v[224:225]
  v_cvt_pk_bf16_f32 v88, v208, v209
  v_cvt_pk_bf16_f32 v89, v210, v211
  v_cvt_pk_bf16_f32 v90, v212, v213
  v_cvt_pk_bf16_f32 v91, v214, v215
  v_dot2c_f32_bf16 v216, v88, v88
  v_dot2c_f32_bf16 v218, v89, v89
  v_dot2c_f32_bf16 v216, v90, v90
  v_dot2c_f32_bf16 v218, v91, v91
  ds_write_b128 v13, v[88:91] offset:0
  v_lshlrev_b32 v208, 16, v92
  v_lshlrev_b32 v210, 16, v93
  v_lshlrev_b32 v212, 16, v94
  v_lshlrev_b32 v214, 16, v95
  v_and_b32 v209, v226, v92
  v_and_b32 v211, v226, v93
  v_and_b32 v213, v226, v94
  v_and_b32 v215, v226, v95
  v_pk_mul_f32 v[208:209], v[208:209], v[224:225]
  v_pk_mul_f32 v[210:211], v[210:211], v[224:225]
  v_pk_mul_f32 v[212:213], v[212:213], v[224:225]
  v_pk_mul_f32 v[214:215], v[214:215], v[224:225]
  v_cvt_pk_bf16_f32 v92, v208, v209
  v_cvt_pk_bf16_f32 v93, v210, v211
  v_cvt_pk_bf16_f32 v94, v212, v213
  v_cvt_pk_bf16_f32 v95, v214, v215
  v_dot2c_f32_bf16 v216, v92, v92
  v_dot2c_f32_bf16 v218, v93, v93
  v_dot2c_f32_bf16 v216, v94, v94
  v_dot2c_f32_bf16 v218, v95, v95
  ds_write_b128 v13, v[92:95] offset:4096
  v_lshlrev_b32 v208, 16, v96
  v_lshlrev_b32 v210, 16, v97
  v_lshlrev_b32 v212, 16, v98
  v_lshlrev_b32 v214, 16, v99
  v_and_b32 v209, v226, v96
  v_and_b32 v211, v226, v97
  v_and_b32 v213, v226, v98
  v_and_b32 v215, v226, v99
  v_pk_mul_f32 v[208:209], v[208:209], v[224:225]
  v_pk_mul_f32 v[210:211], v[210:211], v[224:225]
  v_pk_mul_f32 v[212:213], v[212:213], v[224:225]
  v_pk_mul_f32 v[214:215], v[214:215], v[224:225]
  v_cvt_pk_bf16_f32 v96, v208, v209
  v_cvt_pk_bf16_f32 v97, v210, v211
  v_cvt_pk_bf16_f32 v98, v212, v213
  v_cvt_pk_bf16_f32 v99, v214, v215
  v_dot2c_f32_bf16 v216, v96, v96
  v_dot2c_f32_bf16 v218, v97, v97
  v_dot2c_f32_bf16 v216, v98, v98
  v_dot2c_f32_bf16 v218, v99, v99
  ds_write_b128 v13, v[96:99] offset:8192
  s_nop 1
  v_add_f32 v216, v216, v218
  v_mov_b32 v217, 0
  v_mov_b32 v219, 0
  v_lshlrev_b32 v208, 16, v100
  v_lshlrev_b32 v210, 16, v101
  v_lshlrev_b32 v212, 16, v102
  v_lshlrev_b32 v214, 16, v103
  v_and_b32 v209, v226, v100
  v_and_b32 v211, v226, v101
  v_and_b32 v213, v226, v102
  v_and_b32 v215, v226, v103
  v_pk_mul_f32 v[208:209], v[208:209], v[224:225]
  v_pk_mul_f32 v[210:211], v[210:211], v[224:225]
  v_pk_mul_f32 v[212:213], v[212:213], v[224:225]
  v_pk_mul_f32 v[214:215], v[214:215], v[224:225]
  v_cvt_pk_bf16_f32 v100, v208, v209
  v_cvt_pk_bf16_f32 v101, v210, v211
  v_cvt_pk_bf16_f32 v102, v212, v213
  v_cvt_pk_bf16_f32 v103, v214, v215
  v_dot2c_f32_bf16 v217, v100, v100
  v_dot2c_f32_bf16 v219, v101, v101
  v_dot2c_f32_bf16 v217, v102, v102
  v_dot2c_f32_bf16 v219, v103, v103
  ds_write_b128 v14, v[100:103] offset:0
  v_lshlrev_b32 v208, 16, v104
  v_lshlrev_b32 v210, 16, v105
  v_lshlrev_b32 v212, 16, v106
  v_lshlrev_b32 v214, 16, v107
  v_and_b32 v209, v226, v104
  v_and_b32 v211, v226, v105
  v_and_b32 v213, v226, v106
  v_and_b32 v215, v226, v107
  v_pk_mul_f32 v[208:209], v[208:209], v[224:225]
  v_pk_mul_f32 v[210:211], v[210:211], v[224:225]
  v_pk_mul_f32 v[212:213], v[212:213], v[224:225]
  v_pk_mul_f32 v[214:215], v[214:215], v[224:225]
  v_cvt_pk_bf16_f32 v104, v208, v209
  v_cvt_pk_bf16_f32 v105, v210, v211
  v_cvt_pk_bf16_f32 v106, v212, v213
  v_cvt_pk_bf16_f32 v107, v214, v215
  v_dot2c_f32_bf16 v217, v104, v104
  v_dot2c_f32_bf16 v219, v105, v105
  v_dot2c_f32_bf16 v217, v106, v106
  v_dot2c_f32_bf16 v219, v107, v107
  ds_write_b128 v14, v[104:107] offset:4096
  v_lshlrev_b32 v208, 16, v108
  v_lshlrev_b32 v210, 16, v109
  v_lshlrev_b32 v212, 16, v110
  v_lshlrev_b32 v214, 16, v111
  v_and_b32 v209, v226, v108
  v_and_b32 v211, v226, v109
  v_and_b32 v213, v226, v110
  v_and_b32 v215, v226, v111
  v_pk_mul_f32 v[208:209], v[208:209], v[224:225]
  v_pk_mul_f32 v[210:211], v[210:211], v[224:225]
  v_pk_mul_f32 v[212:213], v[212:213], v[224:225]
  v_pk_mul_f32 v[214:215], v[214:215], v[224:225]
  v_cvt_pk_bf16_f32 v108, v208, v209
  v_cvt_pk_bf16_f32 v109, v210, v211
  v_cvt_pk_bf16_f32 v110, v212, v213
  v_cvt_pk_bf16_f32 v111, v214, v215
  v_dot2c_f32_bf16 v217, v108, v108
  v_dot2c_f32_bf16 v219, v109, v109
  v_dot2c_f32_bf16 v217, v110, v110
  v_dot2c_f32_bf16 v219, v111, v111
  ds_write_b128 v14, v[108:111] offset:8192
  s_nop 1
  v_add_f32 v217, v217, v219
  v_add_f32_dpp v216, v216, v216 quad_perm:[1,0,3,2] row_mask:0xf bank_mask:0xf
  s_nop 0
  v_add_f32_dpp v217, v217, v217 quad_perm:[1,0,3,2] row_mask:0xf bank_mask:0xf
  v_add_f32_dpp v216, v216, v216 quad_perm:[2,3,0,1] row_mask:0xf bank_mask:0xf
  s_nop 0
  v_add_f32_dpp v217, v217, v217 quad_perm:[2,3,0,1] row_mask:0xf bank_mask:0xf
  v_add_f32_dpp v216, v216, v216 row_half_mirror row_mask:0xf bank_mask:0xf
  s_nop 0
  v_add_f32_dpp v217, v217, v217 row_half_mirror row_mask:0xf bank_mask:0xf
  v_cvt_pk_bf16_f32 v216, 0, v216
  v_cvt_pk_bf16_f32 v217, 0, v217
  v_mul_f32 v216, -0.5, v216
  v_mul_f32 v217, -0.5, v217
  ds_write_b32 v5, v216 offset:384
  ds_write_b32 v5, v217 offset:416
  s_waitcnt lgkmcnt(0)
  s_waitcnt vmcnt(24)
  s_barrier
  s_mov_b32 s58, 73728
  buffer_load_dwordx4 v[160:163], v2, s[28:31], s58 offen offset:0 nt
  buffer_load_dwordx4 v[164:167], v2, s[28:31], s58 offen offset:128 nt
  buffer_load_dwordx4 v[168:171], v2, s[28:31], s58 offen offset:256 nt
  buffer_load_dwordx4 v[172:175], v2, s[28:31], s58 offen offset:3072 nt
  buffer_load_dwordx4 v[176:179], v2, s[28:31], s58 offen offset:3200 nt
  buffer_load_dwordx4 v[180:183], v2, s[28:31], s58 offen offset:3328 nt
  s_add_u32 m0, s61, 49152
  s_add_u32 s58, s52, 49152
  buffer_load_dwordx4 v227, s[32:35], s58 offen nt lds
  s_add_u32 m0, s61, 53248
  s_add_u32 s58, s52, 49280
  buffer_load_dwordx4 v227, s[32:35], s58 offen nt lds
  s_add_u32 m0, s61, 57344
  s_add_u32 s58, s52, 49408
  buffer_load_dwordx4 v227, s[32:35], s58 offen nt lds
  s_add_u32 m0, s61, 50176
  s_add_u32 s58, s52, 52224
  buffer_load_dwordx4 v227, s[32:35], s58 offen nt lds
  s_add_u32 m0, s61, 54272
  s_add_u32 s58, s52, 52352
  buffer_load_dwordx4 v227, s[32:35], s58 offen nt lds
  s_add_u32 m0, s61, 58368
  s_add_u32 s58, s52, 52480
  buffer_load_dwordx4 v227, s[32:35], s58 offen nt lds
  s_waitcnt vmcnt(30)
  v_mov_b32 v216, 0
  v_mov_b32 v218, 0
  v_lshlrev_b32 v208, 16, v112
  v_lshlrev_b32 v210, 16, v113
  v_lshlrev_b32 v212, 16, v114
  v_lshlrev_b32 v214, 16, v115
  v_and_b32 v209, v226, v112
  v_and_b32 v211, v226, v113
  v_and_b32 v213, v226, v114
  v_and_b32 v215, v226, v115
  v_pk_mul_f32 v[208:209], v[208:209], v[224:225]
  v_pk_mul_f32 v[210:211], v[210:211], v[224:225]
  v_pk_mul_f32 v[212:213], v[212:213], v[224:225]
  v_pk_mul_f32 v[214:215], v[214:215], v[224:225]
  v_cvt_pk_bf16_f32 v112, v208, v209
  v_cvt_pk_bf16_f32 v113, v210, v211
  v_cvt_pk_bf16_f32 v114, v212, v213
  v_cvt_pk_bf16_f32 v115, v214, v215
  v_dot2c_f32_bf16 v216, v112, v112
  v_dot2c_f32_bf16 v218, v113, v113
  v_dot2c_f32_bf16 v216, v114, v114
  v_dot2c_f32_bf16 v218, v115, v115
  ds_write_b128 v13, v[112:115] offset:12288
  v_lshlrev_b32 v208, 16, v116
  v_lshlrev_b32 v210, 16, v117
  v_lshlrev_b32 v212, 16, v118
  v_lshlrev_b32 v214, 16, v119
  v_and_b32 v209, v226, v116
  v_and_b32 v211, v226, v117
  v_and_b32 v213, v226, v118
  v_and_b32 v215, v226, v119
  v_pk_mul_f32 v[208:209], v[208:209], v[224:225]
  v_pk_mul_f32 v[210:211], v[210:211], v[224:225]
  v_pk_mul_f32 v[212:213], v[212:213], v[224:225]
  v_pk_mul_f32 v[214:215], v[214:215], v[224:225]
  v_cvt_pk_bf16_f32 v116, v208, v209
  v_cvt_pk_bf16_f32 v117, v210, v211
  v_cvt_pk_bf16_f32 v118, v212, v213
  v_cvt_pk_bf16_f32 v119, v214, v215
  v_dot2c_f32_bf16 v216, v116, v116
  v_dot2c_f32_bf16 v218, v117, v117
  v_dot2c_f32_bf16 v216, v118, v118
  v_dot2c_f32_bf16 v218, v119, v119
  ds_write_b128 v13, v[116:119] offset:16384
  v_lshlrev_b32 v208, 16, v120
  v_lshlrev_b32 v210, 16, v121
  v_lshlrev_b32 v212, 16, v122
  v_lshlrev_b32 v214, 16, v123
  v_and_b32 v209, v226, v120
  v_and_b32 v211, v226, v121
  v_and_b32 v213, v226, v122
  v_and_b32 v215, v226, v123
  v_pk_mul_f32 v[208:209], v[208:209], v[224:225]
  v_pk_mul_f32 v[210:211], v[210:211], v[224:225]
  v_pk_mul_f32 v[212:213], v[212:213], v[224:225]
  v_pk_mul_f32 v[214:215], v[214:215], v[224:225]
  v_cvt_pk_bf16_f32 v120, v208, v209
  v_cvt_pk_bf16_f32 v121, v210, v211
  v_cvt_pk_bf16_f32 v122, v212, v213
  v_cvt_pk_bf16_f32 v123, v214, v215
  v_dot2c_f32_bf16 v216, v120, v120
  v_dot2c_f32_bf16 v218, v121, v121
  v_dot2c_f32_bf16 v216, v122, v122
  v_dot2c_f32_bf16 v218, v123, v123
  ds_write_b128 v13, v[120:123] offset:20480
  s_nop 1
  v_add_f32 v216, v216, v218
  v_mov_b32 v217, 0
  v_mov_b32 v219, 0
  v_lshlrev_b32 v208, 16, v124
  v_lshlrev_b32 v210, 16, v125
  v_lshlrev_b32 v212, 16, v126
  v_lshlrev_b32 v214, 16, v127
  v_and_b32 v209, v226, v124
  v_and_b32 v211, v226, v125
  v_and_b32 v213, v226, v126
  v_and_b32 v215, v226, v127
  v_pk_mul_f32 v[208:209], v[208:209], v[224:225]
  v_pk_mul_f32 v[210:211], v[210:211], v[224:225]
  v_pk_mul_f32 v[212:213], v[212:213], v[224:225]
  v_pk_mul_f32 v[214:215], v[214:215], v[224:225]
  v_cvt_pk_bf16_f32 v124, v208, v209
  v_cvt_pk_bf16_f32 v125, v210, v211
  v_cvt_pk_bf16_f32 v126, v212, v213
  v_cvt_pk_bf16_f32 v127, v214, v215
  v_dot2c_f32_bf16 v217, v124, v124
  v_dot2c_f32_bf16 v219, v125, v125
  v_dot2c_f32_bf16 v217, v126, v126
  v_dot2c_f32_bf16 v219, v127, v127
  ds_write_b128 v14, v[124:127] offset:12288
  v_lshlrev_b32 v208, 16, v128
  v_lshlrev_b32 v210, 16, v129
  v_lshlrev_b32 v212, 16, v130
  v_lshlrev_b32 v214, 16, v131
  v_and_b32 v209, v226, v128
  v_and_b32 v211, v226, v129
  v_and_b32 v213, v226, v130
  v_and_b32 v215, v226, v131
  v_pk_mul_f32 v[208:209], v[208:209], v[224:225]
  v_pk_mul_f32 v[210:211], v[210:211], v[224:225]
  v_pk_mul_f32 v[212:213], v[212:213], v[224:225]
  v_pk_mul_f32 v[214:215], v[214:215], v[224:225]
  v_cvt_pk_bf16_f32 v128, v208, v209
  v_cvt_pk_bf16_f32 v129, v210, v211
  v_cvt_pk_bf16_f32 v130, v212, v213
  v_cvt_pk_bf16_f32 v131, v214, v215
  v_dot2c_f32_bf16 v217, v128, v128
  v_dot2c_f32_bf16 v219, v129, v129
  v_dot2c_f32_bf16 v217, v130, v130
  v_dot2c_f32_bf16 v219, v131, v131
  ds_write_b128 v14, v[128:131] offset:16384
  v_lshlrev_b32 v208, 16, v132
  v_lshlrev_b32 v210, 16, v133
  v_lshlrev_b32 v212, 16, v134
  v_lshlrev_b32 v214, 16, v135
  v_and_b32 v209, v226, v132
  v_and_b32 v211, v226, v133
  v_and_b32 v213, v226, v134
  v_and_b32 v215, v226, v135
  v_pk_mul_f32 v[208:209], v[208:209], v[224:225]
  v_pk_mul_f32 v[210:211], v[210:211], v[224:225]
  v_pk_mul_f32 v[212:213], v[212:213], v[224:225]
  v_pk_mul_f32 v[214:215], v[214:215], v[224:225]
  v_cvt_pk_bf16_f32 v132, v208, v209
  v_cvt_pk_bf16_f32 v133, v210, v211
  v_cvt_pk_bf16_f32 v134, v212, v213
  v_cvt_pk_bf16_f32 v135, v214, v215
  v_dot2c_f32_bf16 v217, v132, v132
  v_dot2c_f32_bf16 v219, v133, v133
  v_dot2c_f32_bf16 v217, v134, v134
  v_dot2c_f32_bf16 v219, v135, v135
  ds_write_b128 v14, v[132:135] offset:20480
  s_nop 1
  v_add_f32 v217, v217, v219
  v_add_f32_dpp v216, v216, v216 quad_perm:[1,0,3,2] row_mask:0xf bank_mask:0xf
  s_nop 0
  v_add_f32_dpp v217, v217, v217 quad_perm:[1,0,3,2] row_mask:0xf bank_mask:0xf
  v_add_f32_dpp v216, v216, v216 quad_perm:[2,3,0,1] row_mask:0xf bank_mask:0xf
  s_nop 0
  v_add_f32_dpp v217, v217, v217 quad_perm:[2,3,0,1] row_mask:0xf bank_mask:0xf
  v_add_f32_dpp v216, v216, v216 row_half_mirror row_mask:0xf bank_mask:0xf
  s_nop 0
  v_add_f32_dpp v217, v217, v217 row_half_mirror row_mask:0xf bank_mask:0xf
  v_cvt_pk_bf16_f32 v216, 0, v216
  v_cvt_pk_bf16_f32 v217, 0, v217
  v_mul_f32 v216, -0.5, v216
  v_mul_f32 v217, -0.5, v217
  ds_write_b32 v5, v216 offset:512
  ds_write_b32 v5, v217 offset:544
  s_waitcnt lgkmcnt(0)
  s_waitcnt vmcnt(24)
  s_barrier
  s_mov_b32 s58, 86016
  buffer_load_dwordx4 v[184:187], v2, s[28:31], s58 offen offset:0 nt
  buffer_load_dwordx4 v[188:191], v2, s[28:31], s58 offen offset:128 nt
  buffer_load_dwordx4 v[192:195], v2, s[28:31], s58 offen offset:256 nt
  buffer_load_dwordx4 v[196:199], v2, s[28:31], s58 offen offset:3072 nt
  buffer_load_dwordx4 v[200:203], v2, s[28:31], s58 offen offset:3200 nt
  buffer_load_dwordx4 v[204:207], v2, s[28:31], s58 offen offset:3328 nt
  s_add_u32 m0, s61, 61440
  s_add_u32 s58, s52, 61440
  buffer_load_dwordx4 v227, s[32:35], s58 offen nt lds
  s_add_u32 m0, s61, 65536
  s_add_u32 s58, s52, 61568
  buffer_load_dwordx4 v227, s[32:35], s58 offen nt lds
  s_add_u32 m0, s61, 69632
  s_add_u32 s58, s52, 61696
  buffer_load_dwordx4 v227, s[32:35], s58 offen nt lds
  s_add_u32 m0, s61, 62464
  s_add_u32 s58, s52, 64512
  buffer_load_dwordx4 v227, s[32:35], s58 offen nt lds
  s_add_u32 m0, s61, 66560
  s_add_u32 s58, s52, 64640
  buffer_load_dwordx4 v227, s[32:35], s58 offen nt lds
  s_add_u32 m0, s61, 70656
  s_add_u32 s58, s52, 64768
  buffer_load_dwordx4 v227, s[32:35], s58 offen nt lds
  s_waitcnt vmcnt(30)
  v_mov_b32 v216, 0
  v_mov_b32 v218, 0
  v_lshlrev_b32 v208, 16, v136
  v_lshlrev_b32 v210, 16, v137
  v_lshlrev_b32 v212, 16, v138
  v_lshlrev_b32 v214, 16, v139
  v_and_b32 v209, v226, v136
  v_and_b32 v211, v226, v137
  v_and_b32 v213, v226, v138
  v_and_b32 v215, v226, v139
  v_pk_mul_f32 v[208:209], v[208:209], v[224:225]
  v_pk_mul_f32 v[210:211], v[210:211], v[224:225]
  v_pk_mul_f32 v[212:213], v[212:213], v[224:225]
  v_pk_mul_f32 v[214:215], v[214:215], v[224:225]
  v_cvt_pk_bf16_f32 v136, v208, v209
  v_cvt_pk_bf16_f32 v137, v210, v211
  v_cvt_pk_bf16_f32 v138, v212, v213
  v_cvt_pk_bf16_f32 v139, v214, v215
  v_dot2c_f32_bf16 v216, v136, v136
  v_dot2c_f32_bf16 v218, v137, v137
  v_dot2c_f32_bf16 v216, v138, v138
  v_dot2c_f32_bf16 v218, v139, v139
  ds_write_b128 v13, v[136:139] offset:24576
  v_lshlrev_b32 v208, 16, v140
  v_lshlrev_b32 v210, 16, v141
  v_lshlrev_b32 v212, 16, v142
  v_lshlrev_b32 v214, 16, v143
  v_and_b32 v209, v226, v140
  v_and_b32 v211, v226, v141
  v_and_b32 v213, v226, v142
  v_and_b32 v215, v226, v143
  v_pk_mul_f32 v[208:209], v[208:209], v[224:225]
  v_pk_mul_f32 v[210:211], v[210:211], v[224:225]
  v_pk_mul_f32 v[212:213], v[212:213], v[224:225]
  v_pk_mul_f32 v[214:215], v[214:215], v[224:225]
  v_cvt_pk_bf16_f32 v140, v208, v209
  v_cvt_pk_bf16_f32 v141, v210, v211
  v_cvt_pk_bf16_f32 v142, v212, v213
  v_cvt_pk_bf16_f32 v143, v214, v215
  v_dot2c_f32_bf16 v216, v140, v140
  v_dot2c_f32_bf16 v218, v141, v141
  v_dot2c_f32_bf16 v216, v142, v142
  v_dot2c_f32_bf16 v218, v143, v143
  ds_write_b128 v13, v[140:143] offset:28672
  v_lshlrev_b32 v208, 16, v144
  v_lshlrev_b32 v210, 16, v145
  v_lshlrev_b32 v212, 16, v146
  v_lshlrev_b32 v214, 16, v147
  v_and_b32 v209, v226, v144
  v_and_b32 v211, v226, v145
  v_and_b32 v213, v226, v146
  v_and_b32 v215, v226, v147
  v_pk_mul_f32 v[208:209], v[208:209], v[224:225]
  v_pk_mul_f32 v[210:211], v[210:211], v[224:225]
  v_pk_mul_f32 v[212:213], v[212:213], v[224:225]
  v_pk_mul_f32 v[214:215], v[214:215], v[224:225]
  v_cvt_pk_bf16_f32 v144, v208, v209
  v_cvt_pk_bf16_f32 v145, v210, v211
  v_cvt_pk_bf16_f32 v146, v212, v213
  v_cvt_pk_bf16_f32 v147, v214, v215
  v_dot2c_f32_bf16 v216, v144, v144
  v_dot2c_f32_bf16 v218, v145, v145
  v_dot2c_f32_bf16 v216, v146, v146
  v_dot2c_f32_bf16 v218, v147, v147
  ds_write_b128 v13, v[144:147] offset:32768
  s_nop 1
  v_add_f32 v216, v216, v218
  v_mov_b32 v217, 0
  v_mov_b32 v219, 0
  v_lshlrev_b32 v208, 16, v148
  v_lshlrev_b32 v210, 16, v149
  v_lshlrev_b32 v212, 16, v150
  v_lshlrev_b32 v214, 16, v151
  v_and_b32 v209, v226, v148
  v_and_b32 v211, v226, v149
  v_and_b32 v213, v226, v150
  v_and_b32 v215, v226, v151
  v_pk_mul_f32 v[208:209], v[208:209], v[224:225]
  v_pk_mul_f32 v[210:211], v[210:211], v[224:225]
  v_pk_mul_f32 v[212:213], v[212:213], v[224:225]
  v_pk_mul_f32 v[214:215], v[214:215], v[224:225]
  v_cvt_pk_bf16_f32 v148, v208, v209
  v_cvt_pk_bf16_f32 v149, v210, v211
  v_cvt_pk_bf16_f32 v150, v212, v213
  v_cvt_pk_bf16_f32 v151, v214, v215
  v_dot2c_f32_bf16 v217, v148, v148
  v_dot2c_f32_bf16 v219, v149, v149
  v_dot2c_f32_bf16 v217, v150, v150
  v_dot2c_f32_bf16 v219, v151, v151
  ds_write_b128 v14, v[148:151] offset:24576
  v_lshlrev_b32 v208, 16, v152
  v_lshlrev_b32 v210, 16, v153
  v_lshlrev_b32 v212, 16, v154
  v_lshlrev_b32 v214, 16, v155
  v_and_b32 v209, v226, v152
  v_and_b32 v211, v226, v153
  v_and_b32 v213, v226, v154
  v_and_b32 v215, v226, v155
  v_pk_mul_f32 v[208:209], v[208:209], v[224:225]
  v_pk_mul_f32 v[210:211], v[210:211], v[224:225]
  v_pk_mul_f32 v[212:213], v[212:213], v[224:225]
  v_pk_mul_f32 v[214:215], v[214:215], v[224:225]
  v_cvt_pk_bf16_f32 v152, v208, v209
  v_cvt_pk_bf16_f32 v153, v210, v211
  v_cvt_pk_bf16_f32 v154, v212, v213
  v_cvt_pk_bf16_f32 v155, v214, v215
  v_dot2c_f32_bf16 v217, v152, v152
  v_dot2c_f32_bf16 v219, v153, v153
  v_dot2c_f32_bf16 v217, v154, v154
  v_dot2c_f32_bf16 v219, v155, v155
  ds_write_b128 v14, v[152:155] offset:28672
  v_lshlrev_b32 v208, 16, v156
  v_lshlrev_b32 v210, 16, v157
  v_lshlrev_b32 v212, 16, v158
  v_lshlrev_b32 v214, 16, v159
  v_and_b32 v209, v226, v156
  v_and_b32 v211, v226, v157
  v_and_b32 v213, v226, v158
  v_and_b32 v215, v226, v159
  v_pk_mul_f32 v[208:209], v[208:209], v[224:225]
  v_pk_mul_f32 v[210:211], v[210:211], v[224:225]
  v_pk_mul_f32 v[212:213], v[212:213], v[224:225]
  v_pk_mul_f32 v[214:215], v[214:215], v[224:225]
  v_cvt_pk_bf16_f32 v156, v208, v209
  v_cvt_pk_bf16_f32 v157, v210, v211
  v_cvt_pk_bf16_f32 v158, v212, v213
  v_cvt_pk_bf16_f32 v159, v214, v215
  v_dot2c_f32_bf16 v217, v156, v156
  v_dot2c_f32_bf16 v219, v157, v157
  v_dot2c_f32_bf16 v217, v158, v158
  v_dot2c_f32_bf16 v219, v159, v159
  ds_write_b128 v14, v[156:159] offset:32768
  s_nop 1
  v_add_f32 v217, v217, v219
  v_add_f32_dpp v216, v216, v216 quad_perm:[1,0,3,2] row_mask:0xf bank_mask:0xf
  s_nop 0
  v_add_f32_dpp v217, v217, v217 quad_perm:[1,0,3,2] row_mask:0xf bank_mask:0xf
  v_add_f32_dpp v216, v216, v216 quad_perm:[2,3,0,1] row_mask:0xf bank_mask:0xf
  s_nop 0
  v_add_f32_dpp v217, v217, v217 quad_perm:[2,3,0,1] row_mask:0xf bank_mask:0xf
  v_add_f32_dpp v216, v216, v216 row_half_mirror row_mask:0xf bank_mask:0xf
  s_nop 0
  v_add_f32_dpp v217, v217, v217 row_half_mirror row_mask:0xf bank_mask:0xf
  v_cvt_pk_bf16_f32 v216, 0, v216
  v_cvt_pk_bf16_f32 v217, 0, v217
  v_mul_f32 v216, -0.5, v216
  v_mul_f32 v217, -0.5, v217
  ds_write_b32 v5, v216 offset:640
  ds_write_b32 v5, v217 offset:672
  s_waitcnt lgkmcnt(0)
  s_waitcnt vmcnt(24)
  s_barrier
  s_cmp_lg_u32 s24, 6
  s_cbranch_scc1 L_sy4
  s_lshl_b32 s58, s22, 3
  v_mov_b32 v236, s58
  s_mov_b32 exec_lo, 1
  s_mov_b32 exec_hi, 0
  global_load_dword v230, v236, s[18:19] offset:4 sc1
  s_mov_b64 exec, -1
L_sy4:
  s_add_u32 m0, s61, 73728
  s_add_u32 s58, s52, 73728
  buffer_load_dwordx4 v227, s[32:35], s58 offen nt lds
  s_add_u32 m0, s61, 77824
  s_add_u32 s58, s52, 73856
  buffer_load_dwordx4 v227, s[32:35], s58 offen nt lds
  s_add_u32 m0, s61, 81920
  s_add_u32 s58, s52, 73984
  buffer_load_dwordx4 v227, s[32:35], s58 offen nt lds
  s_add_u32 m0, s61, 74752
  s_add_u32 s58, s52, 76800
  buffer_load_dwordx4 v227, s[32:35], s58 offen nt lds
  s_add_u32 m0, s61, 78848
  s_add_u32 s58, s52, 76928
  buffer_load_dwordx4 v227, s[32:35], s58 offen nt lds
  s_add_u32 m0, s61, 82944
  s_add_u32 s58, s52, 77056
  buffer_load_dwordx4 v227, s[32:35], s58 offen nt lds
  s_add_u32 m0, s61, 86016
  s_add_u32 s58, s52, 86016
  buffer_load_dwordx4 v227, s[32:35], s58 offen nt lds
  s_add_u32 m0, s61, 90112
  s_add_u32 s58, s52, 86144
  buffer_load_dwordx4 v227, s[32:35], s58 offen nt lds
  s_add_u32 m0, s61, 94208
  s_add_u32 s58, s52, 86272
  buffer_load_dwordx4 v227, s[32:35], s58 offen nt lds
  s_add_u32 m0, s61, 87040
  s_add_u32 s58, s52, 89088
  buffer_load_dwordx4 v227, s[32:35], s58 offen nt lds
  s_add_u32 m0, s61, 91136
  s_add_u32 s58, s52, 89216
  buffer_load_dwordx4 v227, s[32:35], s58 offen nt lds
  s_add_u32 m0, s61, 95232
  s_add_u32 s58, s52, 89344
  buffer_load_dwordx4 v227, s[32:35], s58 offen nt lds
  s_waitcnt vmcnt(30)
  v_mov_b32 v216, 0
  v_mov_b32 v218, 0
  v_lshlrev_b32 v208, 16, v160
  v_lshlrev_b32 v210, 16, v161
  v_lshlrev_b32 v212, 16, v162
  v_lshlrev_b32 v214, 16, v163
  v_and_b32 v209, v226, v160
  v_and_b32 v211, v226, v161
  v_and_b32 v213, v226, v162
  v_and_b32 v215, v226, v163
  v_pk_mul_f32 v[208:209], v[208:209], v[224:225]
  v_pk_mul_f32 v[210:211], v[210:211], v[224:225]
  v_pk_mul_f32 v[212:213], v[212:213], v[224:225]
  v_pk_mul_f32 v[214:215], v[214:215], v[224:225]
  v_cvt_pk_bf16_f32 v160, v208, v209
  v_cvt_pk_bf16_f32 v161, v210, v211
  v_cvt_pk_bf16_f32 v162, v212, v213
  v_cvt_pk_bf16_f32 v163, v214, v215
  v_dot2c_f32_bf16 v216, v160, v160
  v_dot2c_f32_bf16 v218, v161, v161
  v_dot2c_f32_bf16 v216, v162, v162
  v_dot2c_f32_bf16 v218, v163, v163
  ds_write_b128 v13, v[160:163] offset:0
  v_lshlrev_b32 v208, 16, v164
  v_lshlrev_b32 v210, 16, v165
  v_lshlrev_b32 v212, 16, v166
  v_lshlrev_b32 v214, 16, v167
  v_and_b32 v209, v226, v164
  v_and_b32 v211, v226, v165
  v_and_b32 v213, v226, v166
  v_and_b32 v215, v226, v167
  v_pk_mul_f32 v[208:209], v[208:209], v[224:225]
  v_pk_mul_f32 v[210:211], v[210:211], v[224:225]
  v_pk_mul_f32 v[212:213], v[212:213], v[224:225]
  v_pk_mul_f32 v[214:215], v[214:215], v[224:225]
  v_cvt_pk_bf16_f32 v164, v208, v209
  v_cvt_pk_bf16_f32 v165, v210, v211
  v_cvt_pk_bf16_f32 v166, v212, v213
  v_cvt_pk_bf16_f32 v167, v214, v215
  v_dot2c_f32_bf16 v216, v164, v164
  v_dot2c_f32_bf16 v218, v165, v165
  v_dot2c_f32_bf16 v216, v166, v166
  v_dot2c_f32_bf16 v218, v167, v167
  ds_write_b128 v13, v[164:167] offset:4096
  v_lshlrev_b32 v208, 16, v168
  v_lshlrev_b32 v210, 16, v169
  v_lshlrev_b32 v212, 16, v170
  v_lshlrev_b32 v214, 16, v171
  v_and_b32 v209, v226, v168
  v_and_b32 v211, v226, v169
  v_and_b32 v213, v226, v170
  v_and_b32 v215, v226, v171
  v_pk_mul_f32 v[208:209], v[208:209], v[224:225]
  v_pk_mul_f32 v[210:211], v[210:211], v[224:225]
  v_pk_mul_f32 v[212:213], v[212:213], v[224:225]
  v_pk_mul_f32 v[214:215], v[214:215], v[224:225]
  v_cvt_pk_bf16_f32 v168, v208, v209
  v_cvt_pk_bf16_f32 v169, v210, v211
  v_cvt_pk_bf16_f32 v170, v212, v213
  v_cvt_pk_bf16_f32 v171, v214, v215
  v_dot2c_f32_bf16 v216, v168, v168
  v_dot2c_f32_bf16 v218, v169, v169
  v_dot2c_f32_bf16 v216, v170, v170
  v_dot2c_f32_bf16 v218, v171, v171
  ds_write_b128 v13, v[168:171] offset:8192
  s_nop 1
  v_add_f32 v216, v216, v218
  v_mov_b32 v217, 0
  v_mov_b32 v219, 0
  v_lshlrev_b32 v208, 16, v172
  v_lshlrev_b32 v210, 16, v173
  v_lshlrev_b32 v212, 16, v174
  v_lshlrev_b32 v214, 16, v175
  v_and_b32 v209, v226, v172
  v_and_b32 v211, v226, v173
  v_and_b32 v213, v226, v174
  v_and_b32 v215, v226, v175
  v_pk_mul_f32 v[208:209], v[208:209], v[224:225]
  v_pk_mul_f32 v[210:211], v[210:211], v[224:225]
  v_pk_mul_f32 v[212:213], v[212:213], v[224:225]
  v_pk_mul_f32 v[214:215], v[214:215], v[224:225]
  v_cvt_pk_bf16_f32 v172, v208, v209
  v_cvt_pk_bf16_f32 v173, v210, v211
  v_cvt_pk_bf16_f32 v174, v212, v213
  v_cvt_pk_bf16_f32 v175, v214, v215
  v_dot2c_f32_bf16 v217, v172, v172
  v_dot2c_f32_bf16 v219, v173, v173
  v_dot2c_f32_bf16 v217, v174, v174
  v_dot2c_f32_bf16 v219, v175, v175
  ds_write_b128 v14, v[172:175] offset:0
  v_lshlrev_b32 v208, 16, v176
  v_lshlrev_b32 v210, 16, v177
  v_lshlrev_b32 v212, 16, v178
  v_lshlrev_b32 v214, 16, v179
  v_and_b32 v209, v226, v176
  v_and_b32 v211, v226, v177
  v_and_b32 v213, v226, v178
  v_and_b32 v215, v226, v179
  v_pk_mul_f32 v[208:209], v[208:209], v[224:225]
  v_pk_mul_f32 v[210:211], v[210:211], v[224:225]
  v_pk_mul_f32 v[212:213], v[212:213], v[224:225]
  v_pk_mul_f32 v[214:215], v[214:215], v[224:225]
  v_cvt_pk_bf16_f32 v176, v208, v209
  v_cvt_pk_bf16_f32 v177, v210, v211
  v_cvt_pk_bf16_f32 v178, v212, v213
  v_cvt_pk_bf16_f32 v179, v214, v215
  v_dot2c_f32_bf16 v217, v176, v176
  v_dot2c_f32_bf16 v219, v177, v177
  v_dot2c_f32_bf16 v217, v178, v178
  v_dot2c_f32_bf16 v219, v179, v179
  ds_write_b128 v14, v[176:179] offset:4096
  v_lshlrev_b32 v208, 16, v180
  v_lshlrev_b32 v210, 16, v181
  v_lshlrev_b32 v212, 16, v182
  v_lshlrev_b32 v214, 16, v183
  v_and_b32 v209, v226, v180
  v_and_b32 v211, v226, v181
  v_and_b32 v213, v226, v182
  v_and_b32 v215, v226, v183
  v_pk_mul_f32 v[208:209], v[208:209], v[224:225]
  v_pk_mul_f32 v[210:211], v[210:211], v[224:225]
  v_pk_mul_f32 v[212:213], v[212:213], v[224:225]
  v_pk_mul_f32 v[214:215], v[214:215], v[224:225]
  v_cvt_pk_bf16_f32 v180, v208, v209
  v_cvt_pk_bf16_f32 v181, v210, v211
  v_cvt_pk_bf16_f32 v182, v212, v213
  v_cvt_pk_bf16_f32 v183, v214, v215
  v_dot2c_f32_bf16 v217, v180, v180
  v_dot2c_f32_bf16 v219, v181, v181
  v_dot2c_f32_bf16 v217, v182, v182
  v_dot2c_f32_bf16 v219, v183, v183
  ds_write_b128 v14, v[180:183] offset:8192
  s_nop 1
  v_add_f32 v217, v217, v219
  v_add_f32_dpp v216, v216, v216 quad_perm:[1,0,3,2] row_mask:0xf bank_mask:0xf
  s_nop 0
  v_add_f32_dpp v217, v217, v217 quad_perm:[1,0,3,2] row_mask:0xf bank_mask:0xf
  v_add_f32_dpp v216, v216, v216 quad_perm:[2,3,0,1] row_mask:0xf bank_mask:0xf
  s_nop 0
  v_add_f32_dpp v217, v217, v217 quad_perm:[2,3,0,1] row_mask:0xf bank_mask:0xf
  v_add_f32_dpp v216, v216, v216 row_half_mirror row_mask:0xf bank_mask:0xf
  s_nop 0
  v_add_f32_dpp v217, v217, v217 row_half_mirror row_mask:0xf bank_mask:0xf
  v_cvt_pk_bf16_f32 v216, 0, v216
  v_cvt_pk_bf16_f32 v217, 0, v217
  v_mul_f32 v216, -0.5, v216
  v_mul_f32 v217, -0.5, v217
  ds_write_b32 v5, v216 offset:768
  ds_write_b32 v5, v217 offset:800
  s_waitcnt lgkmcnt(0)
  s_waitcnt vmcnt(24)
  s_barrier
  s_mov_b32 s58, 0
  buffer_load_dwordx4 v[16:19], v2, s[64:67], s58 offen offset:0 nt
  buffer_load_dwordx4 v[20:23], v2, s[64:67], s58 offen offset:128 nt
  buffer_load_dwordx4 v[24:27], v2, s[64:67], s58 offen offset:256 nt
  buffer_load_dwordx4 v[28:31], v2, s[64:67], s58 offen offset:3072 nt
  buffer_load_dwordx4 v[32:35], v2, s[64:67], s58 offen offset:3200 nt
  buffer_load_dwordx4 v[36:39], v2, s[64:67], s58 offen offset:3328 nt
  s_mov_b32 s58, 12288
  buffer_load_dwordx4 v[40:43], v2, s[64:67], s58 offen offset:0 nt
  buffer_load_dwordx4 v[44:47], v2, s[64:67], s58 offen offset:128 nt
  buffer_load_dwordx4 v[48:51], v2, s[64:67], s58 offen offset:256 nt
  buffer_load_dwordx4 v[52:55], v2, s[64:67], s58 offen offset:3072 nt
  buffer_load_dwordx4 v[56:59], v2, s[64:67], s58 offen offset:3200 nt
  buffer_load_dwordx4 v[60:63], v2, s[64:67], s58 offen offset:3328 nt
  s_waitcnt vmcnt(30)
  v_mov_b32 v216, 0
  v_mov_b32 v218, 0
  v_lshlrev_b32 v208, 16, v184
  v_lshlrev_b32 v210, 16, v185
  v_lshlrev_b32 v212, 16, v186
  v_lshlrev_b32 v214, 16, v187
  v_and_b32 v209, v226, v184
  v_and_b32 v211, v226, v185
  v_and_b32 v213, v226, v186
  v_and_b32 v215, v226, v187
  v_pk_mul_f32 v[208:209], v[208:209], v[224:225]
  v_pk_mul_f32 v[210:211], v[210:211], v[224:225]
  v_pk_mul_f32 v[212:213], v[212:213], v[224:225]
  v_pk_mul_f32 v[214:215], v[214:215], v[224:225]
  v_cvt_pk_bf16_f32 v184, v208, v209
  v_cvt_pk_bf16_f32 v185, v210, v211
  v_cvt_pk_bf16_f32 v186, v212, v213
  v_cvt_pk_bf16_f32 v187, v214, v215
  v_dot2c_f32_bf16 v216, v184, v184
  v_dot2c_f32_bf16 v218, v185, v185
  v_dot2c_f32_bf16 v216, v186, v186
  v_dot2c_f32_bf16 v218, v187, v187
  ds_write_b128 v13, v[184:187] offset:12288
  v_lshlrev_b32 v208, 16, v188
  v_lshlrev_b32 v210, 16, v189
  v_lshlrev_b32 v212, 16, v190
  v_lshlrev_b32 v214, 16, v191
  v_and_b32 v209, v226, v188
  v_and_b32 v211, v226, v189
  v_and_b32 v213, v226, v190
  v_and_b32 v215, v226, v191
  v_pk_mul_f32 v[208:209], v[208:209], v[224:225]
  v_pk_mul_f32 v[210:211], v[210:211], v[224:225]
  v_pk_mul_f32 v[212:213], v[212:213], v[224:225]
  v_pk_mul_f32 v[214:215], v[214:215], v[224:225]
  v_cvt_pk_bf16_f32 v188, v208, v209
  v_cvt_pk_bf16_f32 v189, v210, v211
  v_cvt_pk_bf16_f32 v190, v212, v213
  v_cvt_pk_bf16_f32 v191, v214, v215
  v_dot2c_f32_bf16 v216, v188, v188
  v_dot2c_f32_bf16 v218, v189, v189
  v_dot2c_f32_bf16 v216, v190, v190
  v_dot2c_f32_bf16 v218, v191, v191
  ds_write_b128 v13, v[188:191] offset:16384
  v_lshlrev_b32 v208, 16, v192
  v_lshlrev_b32 v210, 16, v193
  v_lshlrev_b32 v212, 16, v194
  v_lshlrev_b32 v214, 16, v195
  v_and_b32 v209, v226, v192
  v_and_b32 v211, v226, v193
  v_and_b32 v213, v226, v194
  v_and_b32 v215, v226, v195
  v_pk_mul_f32 v[208:209], v[208:209], v[224:225]
  v_pk_mul_f32 v[210:211], v[210:211], v[224:225]
  v_pk_mul_f32 v[212:213], v[212:213], v[224:225]
  v_pk_mul_f32 v[214:215], v[214:215], v[224:225]
  v_cvt_pk_bf16_f32 v192, v208, v209
  v_cvt_pk_bf16_f32 v193, v210, v211
  v_cvt_pk_bf16_f32 v194, v212, v213
  v_cvt_pk_bf16_f32 v195, v214, v215
  v_dot2c_f32_bf16 v216, v192, v192
  v_dot2c_f32_bf16 v218, v193, v193
  v_dot2c_f32_bf16 v216, v194, v194
  v_dot2c_f32_bf16 v218, v195, v195
  ds_write_b128 v13, v[192:195] offset:20480
  s_nop 1
  v_add_f32 v216, v216, v218
  v_mov_b32 v217, 0
  v_mov_b32 v219, 0
  v_lshlrev_b32 v208, 16, v196
  v_lshlrev_b32 v210, 16, v197
  v_lshlrev_b32 v212, 16, v198
  v_lshlrev_b32 v214, 16, v199
  v_and_b32 v209, v226, v196
  v_and_b32 v211, v226, v197
  v_and_b32 v213, v226, v198
  v_and_b32 v215, v226, v199
  v_pk_mul_f32 v[208:209], v[208:209], v[224:225]
  v_pk_mul_f32 v[210:211], v[210:211], v[224:225]
  v_pk_mul_f32 v[212:213], v[212:213], v[224:225]
  v_pk_mul_f32 v[214:215], v[214:215], v[224:225]
  v_cvt_pk_bf16_f32 v196, v208, v209
  v_cvt_pk_bf16_f32 v197, v210, v211
  v_cvt_pk_bf16_f32 v198, v212, v213
  v_cvt_pk_bf16_f32 v199, v214, v215
  v_dot2c_f32_bf16 v217, v196, v196
  v_dot2c_f32_bf16 v219, v197, v197
  v_dot2c_f32_bf16 v217, v198, v198
  v_dot2c_f32_bf16 v219, v199, v199
  ds_write_b128 v14, v[196:199] offset:12288
  v_lshlrev_b32 v208, 16, v200
  v_lshlrev_b32 v210, 16, v201
  v_lshlrev_b32 v212, 16, v202
  v_lshlrev_b32 v214, 16, v203
  v_and_b32 v209, v226, v200
  v_and_b32 v211, v226, v201
  v_and_b32 v213, v226, v202
  v_and_b32 v215, v226, v203
  v_pk_mul_f32 v[208:209], v[208:209], v[224:225]
  v_pk_mul_f32 v[210:211], v[210:211], v[224:225]
  v_pk_mul_f32 v[212:213], v[212:213], v[224:225]
  v_pk_mul_f32 v[214:215], v[214:215], v[224:225]
  v_cvt_pk_bf16_f32 v200, v208, v209
  v_cvt_pk_bf16_f32 v201, v210, v211
  v_cvt_pk_bf16_f32 v202, v212, v213
  v_cvt_pk_bf16_f32 v203, v214, v215
  v_dot2c_f32_bf16 v217, v200, v200
  v_dot2c_f32_bf16 v219, v201, v201
  v_dot2c_f32_bf16 v217, v202, v202
  v_dot2c_f32_bf16 v219, v203, v203
  ds_write_b128 v14, v[200:203] offset:16384
  v_lshlrev_b32 v208, 16, v204
  v_lshlrev_b32 v210, 16, v205
  v_lshlrev_b32 v212, 16, v206
  v_lshlrev_b32 v214, 16, v207
  v_and_b32 v209, v226, v204
  v_and_b32 v211, v226, v205
  v_and_b32 v213, v226, v206
  v_and_b32 v215, v226, v207
  v_pk_mul_f32 v[208:209], v[208:209], v[224:225]
  v_pk_mul_f32 v[210:211], v[210:211], v[224:225]
  v_pk_mul_f32 v[212:213], v[212:213], v[224:225]
  v_pk_mul_f32 v[214:215], v[214:215], v[224:225]
  v_cvt_pk_bf16_f32 v204, v208, v209
  v_cvt_pk_bf16_f32 v205, v210, v211
  v_cvt_pk_bf16_f32 v206, v212, v213
  v_cvt_pk_bf16_f32 v207, v214, v215
  v_dot2c_f32_bf16 v217, v204, v204
  v_dot2c_f32_bf16 v219, v205, v205
  v_dot2c_f32_bf16 v217, v206, v206
  v_dot2c_f32_bf16 v219, v207, v207
  ds_write_b128 v14, v[204:207] offset:20480
  s_nop 1
  v_add_f32 v217, v217, v219
  v_add_f32_dpp v216, v216, v216 quad_perm:[1,0,3,2] row_mask:0xf bank_mask:0xf
  s_nop 0
  v_add_f32_dpp v217, v217, v217 quad_perm:[1,0,3,2] row_mask:0xf bank_mask:0xf
  v_add_f32_dpp v216, v216, v216 quad_perm:[2,3,0,1] row_mask:0xf bank_mask:0xf
  s_nop 0
  v_add_f32_dpp v217, v217, v217 quad_perm:[2,3,0,1] row_mask:0xf bank_mask:0xf
  v_add_f32_dpp v216, v216, v216 row_half_mirror row_mask:0xf bank_mask:0xf
  s_nop 0
  v_add_f32_dpp v217, v217, v217 row_half_mirror row_mask:0xf bank_mask:0xf
  v_cvt_pk_bf16_f32 v216, 0, v216
  v_cvt_pk_bf16_f32 v217, 0, v217
  v_mul_f32 v216, -0.5, v216
  v_mul_f32 v217, -0.5, v217
  ds_write_b32 v5, v216 offset:896
  ds_write_b32 v5, v217 offset:928
  s_waitcnt lgkmcnt(0)
  s_waitcnt vmcnt(24)
  s_barrier
  s_mov_b32 s58, 24576
  buffer_load_dwordx4 v[64:67], v2, s[64:67], s58 offen offset:0 nt
  buffer_load_dwordx4 v[68:71], v2, s[64:67], s58 offen offset:128 nt
  buffer_load_dwordx4 v[72:75], v2, s[64:67], s58 offen offset:256 nt
  buffer_load_dwordx4 v[76:79], v2, s[64:67], s58 offen offset:3072 nt
  buffer_load_dwordx4 v[80:83], v2, s[64:67], s58 offen offset:3200 nt
  buffer_load_dwordx4 v[84:87], v2, s[64:67], s58 offen offset:3328 nt
  s_mov_b32 s58, 36864
  buffer_load_dwordx4 v[88:91], v2, s[64:67], s58 offen offset:0 nt
  buffer_load_dwordx4 v[92:95], v2, s[64:67], s58 offen offset:128 nt
  buffer_load_dwordx4 v[96:99], v2, s[64:67], s58 offen offset:256 nt
  buffer_load_dwordx4 v[100:103], v2, s[64:67], s58 offen offset:3072 nt
  buffer_load_dwordx4 v[104:107], v2, s[64:67], s58 offen offset:3200 nt
  buffer_load_dwordx4 v[108:111], v2, s[64:67], s58 offen offset:3328 nt
  s_waitcnt vmcnt(30)
  s_cmp_lg_u32 s24, 6
  s_cbranch_scc1 L_sy5
  v_readfirstlane_b32 s54, v232
  v_readfirstlane_b32 s57, v230
  s_cmp_eq_u32 s54, 0
  s_cselect_b32 s54, s53, s54
  s_lshl_b32 s58, 8, s73
  s_cmp_eq_u32 s57, s58
  s_cselect_b32 s62, 1, 0
  v_mov_b32 v234, s54
  v_mov_b32 v235, s62
  v_mov_b32 v236, 137728
  ds_write_b64 v236, v[234:235] offset:8
  s_waitcnt lgkmcnt(0)
L_sy5:
  s_barrier
  s_mov_b32 s58, 49152
  buffer_load_dwordx4 v[112:115], v2, s[64:67], s58 offen offset:0 nt
  buffer_load_dwordx4 v[116:119], v2, s[64:67], s58 offen offset:128 nt
  buffer_load_dwordx4 v[120:123], v2, s[64:67], s58 offen offset:256 nt
  buffer_load_dwordx4 v[124:127], v2, s[64:67], s58 offen offset:3072 nt
  buffer_load_dwordx4 v[128:131], v2, s[64:67], s58 offen offset:3200 nt
  buffer_load_dwordx4 v[132:135], v2, s[64:67], s58 offen offset:3328 nt
  s_mov_b32 s58, 61440
  buffer_load_dwordx4 v[136:139], v2, s[64:67], s58 offen offset:0 nt
  buffer_load_dwordx4 v[140:143], v2, s[64:67], s58 offen offset:128 nt
  buffer_load_dwordx4 v[144:147], v2, s[64:67], s58 offen offset:256 nt
  buffer_load_dwordx4 v[148:151], v2, s[64:67], s58 offen offset:3072 nt
  buffer_load_dwordx4 v[152:155], v2, s[64:67], s58 offen offset:3200 nt
  buffer_load_dwordx4 v[156:159], v2, s[64:67], s58 offen offset:3328 nt
  s_waitcnt vmcnt(30)
  v_mov_b32 v216, 0
  v_mov_b32 v218, 0
  v_lshlrev_b32 v208, 16, v16
  v_lshlrev_b32 v210, 16, v17
  v_lshlrev_b32 v212, 16, v18
  v_lshlrev_b32 v214, 16, v19
  v_and_b32 v209, v226, v16
  v_and_b32 v211, v226, v17
  v_and_b32 v213, v226, v18
  v_and_b32 v215, v226, v19
  v_pk_mul_f32 v[208:209], v[208:209], v[224:225]
  v_pk_mul_f32 v[210:211], v[210:211], v[224:225]
  v_pk_mul_f32 v[212:213], v[212:213], v[224:225]
  v_pk_mul_f32 v[214:215], v[214:215], v[224:225]
  v_cvt_pk_bf16_f32 v16, v208, v209
  v_cvt_pk_bf16_f32 v17, v210, v211
  v_cvt_pk_bf16_f32 v18, v212, v213
  v_cvt_pk_bf16_f32 v19, v214, v215
  v_dot2c_f32_bf16 v216, v16, v16
  v_dot2c_f32_bf16 v218, v17, v17
  v_dot2c_f32_bf16 v216, v18, v18
  v_dot2c_f32_bf16 v218, v19, v19
  ds_write_b128 v3, v[16:19] offset:0
  v_lshlrev_b32 v208, 16, v20
  v_lshlrev_b32 v210, 16, v21
  v_lshlrev_b32 v212, 16, v22
  v_lshlrev_b32 v214, 16, v23
  v_and_b32 v209, v226, v20
  v_and_b32 v211, v226, v21
  v_and_b32 v213, v226, v22
  v_and_b32 v215, v226, v23
  v_pk_mul_f32 v[208:209], v[208:209], v[224:225]
  v_pk_mul_f32 v[210:211], v[210:211], v[224:225]
  v_pk_mul_f32 v[212:213], v[212:213], v[224:225]
  v_pk_mul_f32 v[214:215], v[214:215], v[224:225]
  v_cvt_pk_bf16_f32 v20, v208, v209
  v_cvt_pk_bf16_f32 v21, v210, v211
  v_cvt_pk_bf16_f32 v22, v212, v213
  v_cvt_pk_bf16_f32 v23, v214, v215
  v_dot2c_f32_bf16 v216, v20, v20
  v_dot2c_f32_bf16 v218, v21, v21
  v_dot2c_f32_bf16 v216, v22, v22
  v_dot2c_f32_bf16 v218, v23, v23
  ds_write_b128 v3, v[20:23] offset:4096
  v_lshlrev_b32 v208, 16, v24
  v_lshlrev_b32 v210, 16, v25
  v_lshlrev_b32 v212, 16, v26
  v_lshlrev_b32 v214, 16, v27
  v_and_b32 v209, v226, v24
  v_and_b32 v211, v226, v25
  v_and_b32 v213, v226, v26
  v_and_b32 v215, v226, v27
  v_pk_mul_f32 v[208:209], v[208:209], v[224:225]
  v_pk_mul_f32 v[210:211], v[210:211], v[224:225]
  v_pk_mul_f32 v[212:213], v[212:213], v[224:225]
  v_pk_mul_f32 v[214:215], v[214:215], v[224:225]
  v_cvt_pk_bf16_f32 v24, v208, v209
  v_cvt_pk_bf16_f32 v25, v210, v211
  v_cvt_pk_bf16_f32 v26, v212, v213
  v_cvt_pk_bf16_f32 v27, v214, v215
  v_dot2c_f32_bf16 v216, v24, v24
  v_dot2c_f32_bf16 v218, v25, v25
  v_dot2c_f32_bf16 v216, v26, v26
  v_dot2c_f32_bf16 v218, v27, v27
  ds_write_b128 v3, v[24:27] offset:8192
  s_nop 1
  v_add_f32 v216, v216, v218
  v_mov_b32 v217, 0
  v_mov_b32 v219, 0
  v_lshlrev_b32 v208, 16, v28
  v_lshlrev_b32 v210, 16, v29
  v_lshlrev_b32 v212, 16, v30
  v_lshlrev_b32 v214, 16, v31
  v_and_b32 v209, v226, v28
  v_and_b32 v211, v226, v29
  v_and_b32 v213, v226, v30
  v_and_b32 v215, v226, v31
  v_pk_mul_f32 v[208:209], v[208:209], v[224:225]
  v_pk_mul_f32 v[210:211], v[210:211], v[224:225]
  v_pk_mul_f32 v[212:213], v[212:213], v[224:225]
  v_pk_mul_f32 v[214:215], v[214:215], v[224:225]
  v_cvt_pk_bf16_f32 v28, v208, v209
  v_cvt_pk_bf16_f32 v29, v210, v211
  v_cvt_pk_bf16_f32 v30, v212, v213
  v_cvt_pk_bf16_f32 v31, v214, v215
  v_dot2c_f32_bf16 v217, v28, v28
  v_dot2c_f32_bf16 v219, v29, v29
  v_dot2c_f32_bf16 v217, v30, v30
  v_dot2c_f32_bf16 v219, v31, v31
  ds_write_b128 v4, v[28:31] offset:0
  v_lshlrev_b32 v208, 16, v32
  v_lshlrev_b32 v210, 16, v33
  v_lshlrev_b32 v212, 16, v34
  v_lshlrev_b32 v214, 16, v35
  v_and_b32 v209, v226, v32
  v_and_b32 v211, v226, v33
  v_and_b32 v213, v226, v34
  v_and_b32 v215, v226, v35
  v_pk_mul_f32 v[208:209], v[208:209], v[224:225]
  v_pk_mul_f32 v[210:211], v[210:211], v[224:225]
  v_pk_mul_f32 v[212:213], v[212:213], v[224:225]
  v_pk_mul_f32 v[214:215], v[214:215], v[224:225]
  v_cvt_pk_bf16_f32 v32, v208, v209
  v_cvt_pk_bf16_f32 v33, v210, v211
  v_cvt_pk_bf16_f32 v34, v212, v213
  v_cvt_pk_bf16_f32 v35, v214, v215
  v_dot2c_f32_bf16 v217, v32, v32
  v_dot2c_f32_bf16 v219, v33, v33
  v_dot2c_f32_bf16 v217, v34, v34
  v_dot2c_f32_bf16 v219, v35, v35
  ds_write_b128 v4, v[32:35] offset:4096
  v_lshlrev_b32 v208, 16, v36
  v_lshlrev_b32 v210, 16, v37
  v_lshlrev_b32 v212, 16, v38
  v_lshlrev_b32 v214, 16, v39
  v_and_b32 v209, v226, v36
  v_and_b32 v211, v226, v37
  v_and_b32 v213, v226, v38
  v_and_b32 v215, v226, v39
  v_pk_mul_f32 v[208:209], v[208:209], v[224:225]
  v_pk_mul_f32 v[210:211], v[210:211], v[224:225]
  v_pk_mul_f32 v[212:213], v[212:213], v[224:225]
  v_pk_mul_f32 v[214:215], v[214:215], v[224:225]
  v_cvt_pk_bf16_f32 v36, v208, v209
  v_cvt_pk_bf16_f32 v37, v210, v211
  v_cvt_pk_bf16_f32 v38, v212, v213
  v_cvt_pk_bf16_f32 v39, v214, v215
  v_dot2c_f32_bf16 v217, v36, v36
  v_dot2c_f32_bf16 v219, v37, v37
  v_dot2c_f32_bf16 v217, v38, v38
  v_dot2c_f32_bf16 v219, v39, v39
  ds_write_b128 v4, v[36:39] offset:8192
  s_nop 1
  v_add_f32 v217, v217, v219
  v_add_f32_dpp v216, v216, v216 quad_perm:[1,0,3,2] row_mask:0xf bank_mask:0xf
  s_nop 0
  v_add_f32_dpp v217, v217, v217 quad_perm:[1,0,3,2] row_mask:0xf bank_mask:0xf
  v_add_f32_dpp v216, v216, v216 quad_perm:[2,3,0,1] row_mask:0xf bank_mask:0xf
  s_nop 0
  v_add_f32_dpp v217, v217, v217 quad_perm:[2,3,0,1] row_mask:0xf bank_mask:0xf
  v_add_f32_dpp v216, v216, v216 row_half_mirror row_mask:0xf bank_mask:0xf
  s_nop 0
  v_add_f32_dpp v217, v217, v217 row_half_mirror row_mask:0xf bank_mask:0xf
  v_cvt_pk_bf16_f32 v216, 0, v216
  v_cvt_pk_bf16_f32 v217, 0, v217
  v_mul_f32 v216, -0.5, v216
  v_mul_f32 v217, -0.5, v217
  ds_write_b32 v5, v216 offset:1024
  ds_write_b32 v5, v217 offset:1056
  v_add_u32 v3, 12288, v3
  v_add_u32 v4, 12288, v4
  s_waitcnt lgkmcnt(0)
  s_waitcnt vmcnt(36)
  s_barrier
  s_cmp_lg_u32 s24, 6
  s_cbranch_scc1 L_sy6
  v_and_b32 v234, 8, v1
  v_lshlrev_b32 v234, 4, v234
  v_add_u32 v234, 256, v234
  s_mov_b32 exec_lo, 0xffff
  s_mov_b32 exec_hi, 0
  global_load_dword v235, v234, s[26:27]
  s_mov_b64 exec, -1
L_sy6:
  s_mov_b32 s58, 73728
  buffer_load_dwordx4 v[160:163], v2, s[64:67], s58 offen offset:0 nt
  buffer_load_dwordx4 v[164:167], v2, s[64:67], s58 offen offset:128 nt
  buffer_load_dwordx4 v[168:171], v2, s[64:67], s58 offen offset:256 nt
  buffer_load_dwordx4 v[172:175], v2, s[64:67], s58 offen offset:3072 nt
  buffer_load_dwordx4 v[176:179], v2, s[64:67], s58 offen offset:3200 nt
  buffer_load_dwordx4 v[180:183], v2, s[64:67], s58 offen offset:3328 nt
  s_mov_b32 s58, 86016
  buffer_load_dwordx4 v[184:187], v2, s[64:67], s58 offen offset:0 nt
  buffer_load_dwordx4 v[188:191], v2, s[64:67], s58 offen offset:128 nt
  buffer_load_dwordx4 v[192:195], v2, s[64:67], s58 offen offset:256 nt
  buffer_load_dwordx4 v[196:199], v2, s[64:67], s58 offen offset:3072 nt
  buffer_load_dwordx4 v[200:203], v2, s[64:67], s58 offen offset:3200 nt
  buffer_load_dwordx4 v[204:207], v2, s[64:67], s58 offen offset:3328 nt
  s_waitcnt vmcnt(36)
  v_mov_b32 v216, 0
  v_mov_b32 v218, 0
  v_lshlrev_b32 v208, 16, v40
  v_lshlrev_b32 v210, 16, v41
  v_lshlrev_b32 v212, 16, v42
  v_lshlrev_b32 v214, 16, v43
  v_and_b32 v209, v226, v40
  v_and_b32 v211, v226, v41
  v_and_b32 v213, v226, v42
  v_and_b32 v215, v226, v43
  v_pk_mul_f32 v[208:209], v[208:209], v[224:225]
  v_pk_mul_f32 v[210:211], v[210:211], v[224:225]
  v_pk_mul_f32 v[212:213], v[212:213], v[224:225]
  v_pk_mul_f32 v[214:215], v[214:215], v[224:225]
  v_cvt_pk_bf16_f32 v40, v208, v209
  v_cvt_pk_bf16_f32 v41, v210, v211
  v_cvt_pk_bf16_f32 v42, v212, v213
  v_cvt_pk_bf16_f32 v43, v214, v215
  v_dot2c_f32_bf16 v216, v40, v40
  v_dot2c_f32_bf16 v218, v41, v41
  v_dot2c_f32_bf16 v216, v42, v42
  v_dot2c_f32_bf16 v218, v43, v43
  ds_write_b128 v3, v[40:43] offset:0
  v_lshlrev_b32 v208, 16, v44
  v_lshlrev_b32 v210, 16, v45
  v_lshlrev_b32 v212, 16, v46
  v_lshlrev_b32 v214, 16, v47
  v_and_b32 v209, v226, v44
  v_and_b32 v211, v226, v45
  v_and_b32 v213, v226, v46
  v_and_b32 v215, v226, v47
  v_pk_mul_f32 v[208:209], v[208:209], v[224:225]
  v_pk_mul_f32 v[210:211], v[210:211], v[224:225]
  v_pk_mul_f32 v[212:213], v[212:213], v[224:225]
  v_pk_mul_f32 v[214:215], v[214:215], v[224:225]
  v_cvt_pk_bf16_f32 v44, v208, v209
  v_cvt_pk_bf16_f32 v45, v210, v211
  v_cvt_pk_bf16_f32 v46, v212, v213
  v_cvt_pk_bf16_f32 v47, v214, v215
  v_dot2c_f32_bf16 v216, v44, v44
  v_dot2c_f32_bf16 v218, v45, v45
  v_dot2c_f32_bf16 v216, v46, v46
  v_dot2c_f32_bf16 v218, v47, v47
  ds_write_b128 v3, v[44:47] offset:4096
  v_lshlrev_b32 v208, 16, v48
  v_lshlrev_b32 v210, 16, v49
  v_lshlrev_b32 v212, 16, v50
  v_lshlrev_b32 v214, 16, v51
  v_and_b32 v209, v226, v48
  v_and_b32 v211, v226, v49
  v_and_b32 v213, v226, v50
  v_and_b32 v215, v226, v51
  v_pk_mul_f32 v[208:209], v[208:209], v[224:225]
  v_pk_mul_f32 v[210:211], v[210:211], v[224:225]
  v_pk_mul_f32 v[212:213], v[212:213], v[224:225]
  v_pk_mul_f32 v[214:215], v[214:215], v[224:225]
  v_cvt_pk_bf16_f32 v48, v208, v209
  v_cvt_pk_bf16_f32 v49, v210, v211
  v_cvt_pk_bf16_f32 v50, v212, v213
  v_cvt_pk_bf16_f32 v51, v214, v215
  v_dot2c_f32_bf16 v216, v48, v48
  v_dot2c_f32_bf16 v218, v49, v49
  v_dot2c_f32_bf16 v216, v50, v50
  v_dot2c_f32_bf16 v218, v51, v51
  ds_write_b128 v3, v[48:51] offset:8192
  s_nop 1
  v_add_f32 v216, v216, v218
  v_mov_b32 v217, 0
  v_mov_b32 v219, 0
  v_lshlrev_b32 v208, 16, v52
  v_lshlrev_b32 v210, 16, v53
  v_lshlrev_b32 v212, 16, v54
  v_lshlrev_b32 v214, 16, v55
  v_and_b32 v209, v226, v52
  v_and_b32 v211, v226, v53
  v_and_b32 v213, v226, v54
  v_and_b32 v215, v226, v55
  v_pk_mul_f32 v[208:209], v[208:209], v[224:225]
  v_pk_mul_f32 v[210:211], v[210:211], v[224:225]
  v_pk_mul_f32 v[212:213], v[212:213], v[224:225]
  v_pk_mul_f32 v[214:215], v[214:215], v[224:225]
  v_cvt_pk_bf16_f32 v52, v208, v209
  v_cvt_pk_bf16_f32 v53, v210, v211
  v_cvt_pk_bf16_f32 v54, v212, v213
  v_cvt_pk_bf16_f32 v55, v214, v215
  v_dot2c_f32_bf16 v217, v52, v52
  v_dot2c_f32_bf16 v219, v53, v53
  v_dot2c_f32_bf16 v217, v54, v54
  v_dot2c_f32_bf16 v219, v55, v55
  ds_write_b128 v4, v[52:55] offset:0
  v_lshlrev_b32 v208, 16, v56
  v_lshlrev_b32 v210, 16, v57
  v_lshlrev_b32 v212, 16, v58
  v_lshlrev_b32 v214, 16, v59
  v_and_b32 v209, v226, v56
  v_and_b32 v211, v226, v57
  v_and_b32 v213, v226, v58
  v_and_b32 v215, v226, v59
  v_pk_mul_f32 v[208:209], v[208:209], v[224:225]
  v_pk_mul_f32 v[210:211], v[210:211], v[224:225]
  v_pk_mul_f32 v[212:213], v[212:213], v[224:225]
  v_pk_mul_f32 v[214:215], v[214:215], v[224:225]
  v_cvt_pk_bf16_f32 v56, v208, v209
  v_cvt_pk_bf16_f32 v57, v210, v211
  v_cvt_pk_bf16_f32 v58, v212, v213
  v_cvt_pk_bf16_f32 v59, v214, v215
  v_dot2c_f32_bf16 v217, v56, v56
  v_dot2c_f32_bf16 v219, v57, v57
  v_dot2c_f32_bf16 v217, v58, v58
  v_dot2c_f32_bf16 v219, v59, v59
  ds_write_b128 v4, v[56:59] offset:4096
  v_lshlrev_b32 v208, 16, v60
  v_lshlrev_b32 v210, 16, v61
  v_lshlrev_b32 v212, 16, v62
  v_lshlrev_b32 v214, 16, v63
  v_and_b32 v209, v226, v60
  v_and_b32 v211, v226, v61
  v_and_b32 v213, v226, v62
  v_and_b32 v215, v226, v63
  v_pk_mul_f32 v[208:209], v[208:209], v[224:225]
  v_pk_mul_f32 v[210:211], v[210:211], v[224:225]
  v_pk_mul_f32 v[212:213], v[212:213], v[224:225]
  v_pk_mul_f32 v[214:215], v[214:215], v[224:225]
  v_cvt_pk_bf16_f32 v60, v208, v209
  v_cvt_pk_bf16_f32 v61, v210, v211
  v_cvt_pk_bf16_f32 v62, v212, v213
  v_cvt_pk_bf16_f32 v63, v214, v215
  v_dot2c_f32_bf16 v217, v60, v60
  v_dot2c_f32_bf16 v219, v61, v61
  v_dot2c_f32_bf16 v217, v62, v62
  v_dot2c_f32_bf16 v219, v63, v63
  ds_write_b128 v4, v[60:63] offset:8192
  s_nop 1
  v_add_f32 v217, v217, v219
  v_add_f32_dpp v216, v216, v216 quad_perm:[1,0,3,2] row_mask:0xf bank_mask:0xf
  s_nop 0
  v_add_f32_dpp v217, v217, v217 quad_perm:[1,0,3,2] row_mask:0xf bank_mask:0xf
  v_add_f32_dpp v216, v216, v216 quad_perm:[2,3,0,1] row_mask:0xf bank_mask:0xf
  s_nop 0
  v_add_f32_dpp v217, v217, v217 quad_perm:[2,3,0,1] row_mask:0xf bank_mask:0xf
  v_add_f32_dpp v216, v216, v216 row_half_mirror row_mask:0xf bank_mask:0xf
  s_nop 0
  v_add_f32_dpp v217, v217, v217 row_half_mirror row_mask:0xf bank_mask:0xf
  v_cvt_pk_bf16_f32 v216, 0, v216
  v_cvt_pk_bf16_f32 v217, 0, v217
  v_mul_f32 v216, -0.5, v216
  v_mul_f32 v217, -0.5, v217
  ds_write_b32 v5, v216 offset:1152
  ds_write_b32 v5, v217 offset:1184
  v_add_u32 v3, 12288, v3
  v_add_u32 v4, 12288, v4
  s_waitcnt lgkmcnt(0)
  s_waitcnt vmcnt(30)
  v_mov_b32 v216, 0
  v_mov_b32 v218, 0
  v_lshlrev_b32 v208, 16, v64
  v_lshlrev_b32 v210, 16, v65
  v_lshlrev_b32 v212, 16, v66
  v_lshlrev_b32 v214, 16, v67
  v_and_b32 v209, v226, v64
  v_and_b32 v211, v226, v65
  v_and_b32 v213, v226, v66
  v_and_b32 v215, v226, v67
  v_pk_mul_f32 v[208:209], v[208:209], v[224:225]
  v_pk_mul_f32 v[210:211], v[210:211], v[224:225]
  v_pk_mul_f32 v[212:213], v[212:213], v[224:225]
  v_pk_mul_f32 v[214:215], v[214:215], v[224:225]
  v_cvt_pk_bf16_f32 v64, v208, v209
  v_cvt_pk_bf16_f32 v65, v210, v211
  v_cvt_pk_bf16_f32 v66, v212, v213
  v_cvt_pk_bf16_f32 v67, v214, v215
  v_dot2c_f32_bf16 v216, v64, v64
  v_dot2c_f32_bf16 v218, v65, v65
  v_dot2c_f32_bf16 v216, v66, v66
  v_dot2c_f32_bf16 v218, v67, v67
  ds_write_b128 v3, v[64:67] offset:0
  v_lshlrev_b32 v208, 16, v68
  v_lshlrev_b32 v210, 16, v69
  v_lshlrev_b32 v212, 16, v70
  v_lshlrev_b32 v214, 16, v71
  v_and_b32 v209, v226, v68
  v_and_b32 v211, v226, v69
  v_and_b32 v213, v226, v70
  v_and_b32 v215, v226, v71
  v_pk_mul_f32 v[208:209], v[208:209], v[224:225]
  v_pk_mul_f32 v[210:211], v[210:211], v[224:225]
  v_pk_mul_f32 v[212:213], v[212:213], v[224:225]
  v_pk_mul_f32 v[214:215], v[214:215], v[224:225]
  v_cvt_pk_bf16_f32 v68, v208, v209
  v_cvt_pk_bf16_f32 v69, v210, v211
  v_cvt_pk_bf16_f32 v70, v212, v213
  v_cvt_pk_bf16_f32 v71, v214, v215
  v_dot2c_f32_bf16 v216, v68, v68
  v_dot2c_f32_bf16 v218, v69, v69
  v_dot2c_f32_bf16 v216, v70, v70
  v_dot2c_f32_bf16 v218, v71, v71
  ds_write_b128 v3, v[68:71] offset:4096
  v_lshlrev_b32 v208, 16, v72
  v_lshlrev_b32 v210, 16, v73
  v_lshlrev_b32 v212, 16, v74
  v_lshlrev_b32 v214, 16, v75
  v_and_b32 v209, v226, v72
  v_and_b32 v211, v226, v73
  v_and_b32 v213, v226, v74
  v_and_b32 v215, v226, v75
  v_pk_mul_f32 v[208:209], v[208:209], v[224:225]
  v_pk_mul_f32 v[210:211], v[210:211], v[224:225]
  v_pk_mul_f32 v[212:213], v[212:213], v[224:225]
  v_pk_mul_f32 v[214:215], v[214:215], v[224:225]
  v_cvt_pk_bf16_f32 v72, v208, v209
  v_cvt_pk_bf16_f32 v73, v210, v211
  v_cvt_pk_bf16_f32 v74, v212, v213
  v_cvt_pk_bf16_f32 v75, v214, v215
  v_dot2c_f32_bf16 v216, v72, v72
  v_dot2c_f32_bf16 v218, v73, v73
  v_dot2c_f32_bf16 v216, v74, v74
  v_dot2c_f32_bf16 v218, v75, v75
  ds_write_b128 v3, v[72:75] offset:8192
  s_nop 1
  v_add_f32 v216, v216, v218
  v_mov_b32 v217, 0
  v_mov_b32 v219, 0
  v_lshlrev_b32 v208, 16, v76
  v_lshlrev_b32 v210, 16, v77
  v_lshlrev_b32 v212, 16, v78
  v_lshlrev_b32 v214, 16, v79
  v_and_b32 v209, v226, v76
  v_and_b32 v211, v226, v77
  v_and_b32 v213, v226, v78
  v_and_b32 v215, v226, v79
  v_pk_mul_f32 v[208:209], v[208:209], v[224:225]
  v_pk_mul_f32 v[210:211], v[210:211], v[224:225]
  v_pk_mul_f32 v[212:213], v[212:213], v[224:225]
  v_pk_mul_f32 v[214:215], v[214:215], v[224:225]
  v_cvt_pk_bf16_f32 v76, v208, v209
  v_cvt_pk_bf16_f32 v77, v210, v211
  v_cvt_pk_bf16_f32 v78, v212, v213
  v_cvt_pk_bf16_f32 v79, v214, v215
  v_dot2c_f32_bf16 v217, v76, v76
  v_dot2c_f32_bf16 v219, v77, v77
  v_dot2c_f32_bf16 v217, v78, v78
  v_dot2c_f32_bf16 v219, v79, v79
  ds_write_b128 v4, v[76:79] offset:0
  v_lshlrev_b32 v208, 16, v80
  v_lshlrev_b32 v210, 16, v81
  v_lshlrev_b32 v212, 16, v82
  v_lshlrev_b32 v214, 16, v83
  v_and_b32 v209, v226, v80
  v_and_b32 v211, v226, v81
  v_and_b32 v213, v226, v82
  v_and_b32 v215, v226, v83
  v_pk_mul_f32 v[208:209], v[208:209], v[224:225]
  v_pk_mul_f32 v[210:211], v[210:211], v[224:225]
  v_pk_mul_f32 v[212:213], v[212:213], v[224:225]
  v_pk_mul_f32 v[214:215], v[214:215], v[224:225]
  v_cvt_pk_bf16_f32 v80, v208, v209
  v_cvt_pk_bf16_f32 v81, v210, v211
  v_cvt_pk_bf16_f32 v82, v212, v213
  v_cvt_pk_bf16_f32 v83, v214, v215
  v_dot2c_f32_bf16 v217, v80, v80
  v_dot2c_f32_bf16 v219, v81, v81
  v_dot2c_f32_bf16 v217, v82, v82
  v_dot2c_f32_bf16 v219, v83, v83
  ds_write_b128 v4, v[80:83] offset:4096
  v_lshlrev_b32 v208, 16, v84
  v_lshlrev_b32 v210, 16, v85
  v_lshlrev_b32 v212, 16, v86
  v_lshlrev_b32 v214, 16, v87
  v_and_b32 v209, v226, v84
  v_and_b32 v211, v226, v85
  v_and_b32 v213, v226, v86
  v_and_b32 v215, v226, v87
  v_pk_mul_f32 v[208:209], v[208:209], v[224:225]
  v_pk_mul_f32 v[210:211], v[210:211], v[224:225]
  v_pk_mul_f32 v[212:213], v[212:213], v[224:225]
  v_pk_mul_f32 v[214:215], v[214:215], v[224:225]
  v_cvt_pk_bf16_f32 v84, v208, v209
  v_cvt_pk_bf16_f32 v85, v210, v211
  v_cvt_pk_bf16_f32 v86, v212, v213
  v_cvt_pk_bf16_f32 v87, v214, v215
  v_dot2c_f32_bf16 v217, v84, v84
  v_dot2c_f32_bf16 v219, v85, v85
  v_dot2c_f32_bf16 v217, v86, v86
  v_dot2c_f32_bf16 v219, v87, v87
  ds_write_b128 v4, v[84:87] offset:8192
  s_nop 1
  v_add_f32 v217, v217, v219
  v_add_f32_dpp v216, v216, v216 quad_perm:[1,0,3,2] row_mask:0xf bank_mask:0xf
  s_nop 0
  v_add_f32_dpp v217, v217, v217 quad_perm:[1,0,3,2] row_mask:0xf bank_mask:0xf
  v_add_f32_dpp v216, v216, v216 quad_perm:[2,3,0,1] row_mask:0xf bank_mask:0xf
  s_nop 0
  v_add_f32_dpp v217, v217, v217 quad_perm:[2,3,0,1] row_mask:0xf bank_mask:0xf
  v_add_f32_dpp v216, v216, v216 row_half_mirror row_mask:0xf bank_mask:0xf
  s_nop 0
  v_add_f32_dpp v217, v217, v217 row_half_mirror row_mask:0xf bank_mask:0xf
  v_cvt_pk_bf16_f32 v216, 0, v216
  v_cvt_pk_bf16_f32 v217, 0, v217
  v_mul_f32 v216, -0.5, v216
  v_mul_f32 v217, -0.5, v217
  ds_write_b32 v5, v216 offset:1280
  ds_write_b32 v5, v217 offset:1312
  v_add_u32 v3, 12288, v3
  v_add_u32 v4, 12288, v4
  s_waitcnt lgkmcnt(0)
  s_barrier
  s_barrier
  s_barrier
  s_waitcnt vmcnt(24)
  v_mov_b32 v216, 0
  v_mov_b32 v218, 0
  v_lshlrev_b32 v208, 16, v88
  v_lshlrev_b32 v210, 16, v89
  v_lshlrev_b32 v212, 16, v90
  v_lshlrev_b32 v214, 16, v91
  v_and_b32 v209, v226, v88
  v_and_b32 v211, v226, v89
  v_and_b32 v213, v226, v90
  v_and_b32 v215, v226, v91
  v_pk_mul_f32 v[208:209], v[208:209], v[224:225]
  v_pk_mul_f32 v[210:211], v[210:211], v[224:225]
  v_pk_mul_f32 v[212:213], v[212:213], v[224:225]
  v_pk_mul_f32 v[214:215], v[214:215], v[224:225]
  v_cvt_pk_bf16_f32 v88, v208, v209
  v_cvt_pk_bf16_f32 v89, v210, v211
  v_cvt_pk_bf16_f32 v90, v212, v213
  v_cvt_pk_bf16_f32 v91, v214, v215
  v_dot2c_f32_bf16 v216, v88, v88
  v_dot2c_f32_bf16 v218, v89, v89
  v_dot2c_f32_bf16 v216, v90, v90
  v_dot2c_f32_bf16 v218, v91, v91
  ds_write_b128 v3, v[88:91] offset:0
  v_lshlrev_b32 v208, 16, v92
  v_lshlrev_b32 v210, 16, v93
  v_lshlrev_b32 v212, 16, v94
  v_lshlrev_b32 v214, 16, v95
  v_and_b32 v209, v226, v92
  v_and_b32 v211, v226, v93
  v_and_b32 v213, v226, v94
  v_and_b32 v215, v226, v95
  v_pk_mul_f32 v[208:209], v[208:209], v[224:225]
  v_pk_mul_f32 v[210:211], v[210:211], v[224:225]
  v_pk_mul_f32 v[212:213], v[212:213], v[224:225]
  v_pk_mul_f32 v[214:215], v[214:215], v[224:225]
  v_cvt_pk_bf16_f32 v92, v208, v209
  v_cvt_pk_bf16_f32 v93, v210, v211
  v_cvt_pk_bf16_f32 v94, v212, v213
  v_cvt_pk_bf16_f32 v95, v214, v215
  v_dot2c_f32_bf16 v216, v92, v92
  v_dot2c_f32_bf16 v218, v93, v93
  v_dot2c_f32_bf16 v216, v94, v94
  v_dot2c_f32_bf16 v218, v95, v95
  ds_write_b128 v3, v[92:95] offset:4096
  v_lshlrev_b32 v208, 16, v96
  v_lshlrev_b32 v210, 16, v97
  v_lshlrev_b32 v212, 16, v98
  v_lshlrev_b32 v214, 16, v99
  v_and_b32 v209, v226, v96
  v_and_b32 v211, v226, v97
  v_and_b32 v213, v226, v98
  v_and_b32 v215, v226, v99
  v_pk_mul_f32 v[208:209], v[208:209], v[224:225]
  v_pk_mul_f32 v[210:211], v[210:211], v[224:225]
  v_pk_mul_f32 v[212:213], v[212:213], v[224:225]
  v_pk_mul_f32 v[214:215], v[214:215], v[224:225]
  v_cvt_pk_bf16_f32 v96, v208, v209
  v_cvt_pk_bf16_f32 v97, v210, v211
  v_cvt_pk_bf16_f32 v98, v212, v213
  v_cvt_pk_bf16_f32 v99, v214, v215
  v_dot2c_f32_bf16 v216, v96, v96
  v_dot2c_f32_bf16 v218, v97, v97
  v_dot2c_f32_bf16 v216, v98, v98
  v_dot2c_f32_bf16 v218, v99, v99
  ds_write_b128 v3, v[96:99] offset:8192
  s_nop 1
  v_add_f32 v216, v216, v218
  v_mov_b32 v217, 0
  v_mov_b32 v219, 0
  v_lshlrev_b32 v208, 16, v100
  v_lshlrev_b32 v210, 16, v101
  v_lshlrev_b32 v212, 16, v102
  v_lshlrev_b32 v214, 16, v103
  v_and_b32 v209, v226, v100
  v_and_b32 v211, v226, v101
  v_and_b32 v213, v226, v102
  v_and_b32 v215, v226, v103
  v_pk_mul_f32 v[208:209], v[208:209], v[224:225]
  v_pk_mul_f32 v[210:211], v[210:211], v[224:225]
  v_pk_mul_f32 v[212:213], v[212:213], v[224:225]
  v_pk_mul_f32 v[214:215], v[214:215], v[224:225]
  v_cvt_pk_bf16_f32 v100, v208, v209
  v_cvt_pk_bf16_f32 v101, v210, v211
  v_cvt_pk_bf16_f32 v102, v212, v213
  v_cvt_pk_bf16_f32 v103, v214, v215
  v_dot2c_f32_bf16 v217, v100, v100
  v_dot2c_f32_bf16 v219, v101, v101
  v_dot2c_f32_bf16 v217, v102, v102
  v_dot2c_f32_bf16 v219, v103, v103
  ds_write_b128 v4, v[100:103] offset:0
  v_lshlrev_b32 v208, 16, v104
  v_lshlrev_b32 v210, 16, v105
  v_lshlrev_b32 v212, 16, v106
  v_lshlrev_b32 v214, 16, v107
  v_and_b32 v209, v226, v104
  v_and_b32 v211, v226, v105
  v_and_b32 v213, v226, v106
  v_and_b32 v215, v226, v107
  v_pk_mul_f32 v[208:209], v[208:209], v[224:225]
  v_pk_mul_f32 v[210:211], v[210:211], v[224:225]
  v_pk_mul_f32 v[212:213], v[212:213], v[224:225]
  v_pk_mul_f32 v[214:215], v[214:215], v[224:225]
  v_cvt_pk_bf16_f32 v104, v208, v209
  v_cvt_pk_bf16_f32 v105, v210, v211
  v_cvt_pk_bf16_f32 v106, v212, v213
  v_cvt_pk_bf16_f32 v107, v214, v215
  v_dot2c_f32_bf16 v217, v104, v104
  v_dot2c_f32_bf16 v219, v105, v105
  v_dot2c_f32_bf16 v217, v106, v106
  v_dot2c_f32_bf16 v219, v107, v107
  ds_write_b128 v4, v[104:107] offset:4096
  v_lshlrev_b32 v208, 16, v108
  v_lshlrev_b32 v210, 16, v109
  v_lshlrev_b32 v212, 16, v110
  v_lshlrev_b32 v214, 16, v111
  v_and_b32 v209, v226, v108
  v_and_b32 v211, v226, v109
  v_and_b32 v213, v226, v110
  v_and_b32 v215, v226, v111
  v_pk_mul_f32 v[208:209], v[208:209], v[224:225]
  v_pk_mul_f32 v[210:211], v[210:211], v[224:225]
  v_pk_mul_f32 v[212:213], v[212:213], v[224:225]
  v_pk_mul_f32 v[214:215], v[214:215], v[224:225]
  v_cvt_pk_bf16_f32 v108, v208, v209
  v_cvt_pk_bf16_f32 v109, v210, v211
  v_cvt_pk_bf16_f32 v110, v212, v213
  v_cvt_pk_bf16_f32 v111, v214, v215
  v_dot2c_f32_bf16 v217, v108, v108
  v_dot2c_f32_bf16 v219, v109, v109
  v_dot2c_f32_bf16 v217, v110, v110
  v_dot2c_f32_bf16 v219, v111, v111
  ds_write_b128 v4, v[108:111] offset:8192
  s_nop 1
  v_add_f32 v217, v217, v219
  v_add_f32_dpp v216, v216, v216 quad_perm:[1,0,3,2] row_mask:0xf bank_mask:0xf
  s_nop 0
  v_add_f32_dpp v217, v217, v217 quad_perm:[1,0,3,2] row_mask:0xf bank_mask:0xf
  v_add_f32_dpp v216, v216, v216 quad_perm:[2,3,0,1] row_mask:0xf bank_mask:0xf
  s_nop 0
  v_add_f32_dpp v217, v217, v217 quad_perm:[2,3,0,1] row_mask:0xf bank_mask:0xf
  v_add_f32_dpp v216, v216, v216 row_half_mirror row_mask:0xf bank_mask:0xf
  s_nop 0
  v_add_f32_dpp v217, v217, v217 row_half_mirror row_mask:0xf bank_mask:0xf
  v_cvt_pk_bf16_f32 v216, 0, v216
  v_cvt_pk_bf16_f32 v217, 0, v217
  v_mul_f32 v216, -0.5, v216
  v_mul_f32 v217, -0.5, v217
  ds_write_b32 v5, v216 offset:1408
  ds_write_b32 v5, v217 offset:1440
  v_add_u32 v3, 12288, v3
  v_add_u32 v4, 12288, v4
  s_waitcnt lgkmcnt(0)
  s_barrier
  s_waitcnt vmcnt(18)
  v_mov_b32 v216, 0
  v_mov_b32 v218, 0
  v_lshlrev_b32 v208, 16, v112
  v_lshlrev_b32 v210, 16, v113
  v_lshlrev_b32 v212, 16, v114
  v_lshlrev_b32 v214, 16, v115
  v_and_b32 v209, v226, v112
  v_and_b32 v211, v226, v113
  v_and_b32 v213, v226, v114
  v_and_b32 v215, v226, v115
  v_pk_mul_f32 v[208:209], v[208:209], v[224:225]
  v_pk_mul_f32 v[210:211], v[210:211], v[224:225]
  v_pk_mul_f32 v[212:213], v[212:213], v[224:225]
  v_pk_mul_f32 v[214:215], v[214:215], v[224:225]
  v_cvt_pk_bf16_f32 v112, v208, v209
  v_cvt_pk_bf16_f32 v113, v210, v211
  v_cvt_pk_bf16_f32 v114, v212, v213
  v_cvt_pk_bf16_f32 v115, v214, v215
  v_dot2c_f32_bf16 v216, v112, v112
  v_dot2c_f32_bf16 v218, v113, v113
  v_dot2c_f32_bf16 v216, v114, v114
  v_dot2c_f32_bf16 v218, v115, v115
  ds_write_b128 v3, v[112:115] offset:0
  v_lshlrev_b32 v208, 16, v116
  v_lshlrev_b32 v210, 16, v117
  v_lshlrev_b32 v212, 16, v118
  v_lshlrev_b32 v214, 16, v119
  v_and_b32 v209, v226, v116
  v_and_b32 v211, v226, v117
  v_and_b32 v213, v226, v118
  v_and_b32 v215, v226, v119
  v_pk_mul_f32 v[208:209], v[208:209], v[224:225]
  v_pk_mul_f32 v[210:211], v[210:211], v[224:225]
  v_pk_mul_f32 v[212:213], v[212:213], v[224:225]
  v_pk_mul_f32 v[214:215], v[214:215], v[224:225]
  v_cvt_pk_bf16_f32 v116, v208, v209
  v_cvt_pk_bf16_f32 v117, v210, v211
  v_cvt_pk_bf16_f32 v118, v212, v213
  v_cvt_pk_bf16_f32 v119, v214, v215
  v_dot2c_f32_bf16 v216, v116, v116
  v_dot2c_f32_bf16 v218, v117, v117
  v_dot2c_f32_bf16 v216, v118, v118
  v_dot2c_f32_bf16 v218, v119, v119
  ds_write_b128 v3, v[116:119] offset:4096
  v_lshlrev_b32 v208, 16, v120
  v_lshlrev_b32 v210, 16, v121
  v_lshlrev_b32 v212, 16, v122
  v_lshlrev_b32 v214, 16, v123
  v_and_b32 v209, v226, v120
  v_and_b32 v211, v226, v121
  v_and_b32 v213, v226, v122
  v_and_b32 v215, v226, v123
  v_pk_mul_f32 v[208:209], v[208:209], v[224:225]
  v_pk_mul_f32 v[210:211], v[210:211], v[224:225]
  v_pk_mul_f32 v[212:213], v[212:213], v[224:225]
  v_pk_mul_f32 v[214:215], v[214:215], v[224:225]
  v_cvt_pk_bf16_f32 v120, v208, v209
  v_cvt_pk_bf16_f32 v121, v210, v211
  v_cvt_pk_bf16_f32 v122, v212, v213
  v_cvt_pk_bf16_f32 v123, v214, v215
  v_dot2c_f32_bf16 v216, v120, v120
  v_dot2c_f32_bf16 v218, v121, v121
  v_dot2c_f32_bf16 v216, v122, v122
  v_dot2c_f32_bf16 v218, v123, v123
  ds_write_b128 v3, v[120:123] offset:8192
  s_nop 1
  v_add_f32 v216, v216, v218
  v_mov_b32 v217, 0
  v_mov_b32 v219, 0
  v_lshlrev_b32 v208, 16, v124
  v_lshlrev_b32 v210, 16, v125
  v_lshlrev_b32 v212, 16, v126
  v_lshlrev_b32 v214, 16, v127
  v_and_b32 v209, v226, v124
  v_and_b32 v211, v226, v125
  v_and_b32 v213, v226, v126
  v_and_b32 v215, v226, v127
  v_pk_mul_f32 v[208:209], v[208:209], v[224:225]
  v_pk_mul_f32 v[210:211], v[210:211], v[224:225]
  v_pk_mul_f32 v[212:213], v[212:213], v[224:225]
  v_pk_mul_f32 v[214:215], v[214:215], v[224:225]
  v_cvt_pk_bf16_f32 v124, v208, v209
  v_cvt_pk_bf16_f32 v125, v210, v211
  v_cvt_pk_bf16_f32 v126, v212, v213
  v_cvt_pk_bf16_f32 v127, v214, v215
  v_dot2c_f32_bf16 v217, v124, v124
  v_dot2c_f32_bf16 v219, v125, v125
  v_dot2c_f32_bf16 v217, v126, v126
  v_dot2c_f32_bf16 v219, v127, v127
  ds_write_b128 v4, v[124:127] offset:0
  v_lshlrev_b32 v208, 16, v128
  v_lshlrev_b32 v210, 16, v129
  v_lshlrev_b32 v212, 16, v130
  v_lshlrev_b32 v214, 16, v131
  v_and_b32 v209, v226, v128
  v_and_b32 v211, v226, v129
  v_and_b32 v213, v226, v130
  v_and_b32 v215, v226, v131
  v_pk_mul_f32 v[208:209], v[208:209], v[224:225]
  v_pk_mul_f32 v[210:211], v[210:211], v[224:225]
  v_pk_mul_f32 v[212:213], v[212:213], v[224:225]
  v_pk_mul_f32 v[214:215], v[214:215], v[224:225]
  v_cvt_pk_bf16_f32 v128, v208, v209
  v_cvt_pk_bf16_f32 v129, v210, v211
  v_cvt_pk_bf16_f32 v130, v212, v213
  v_cvt_pk_bf16_f32 v131, v214, v215
  v_dot2c_f32_bf16 v217, v128, v128
  v_dot2c_f32_bf16 v219, v129, v129
  v_dot2c_f32_bf16 v217, v130, v130
  v_dot2c_f32_bf16 v219, v131, v131
  ds_write_b128 v4, v[128:131] offset:4096
  v_lshlrev_b32 v208, 16, v132
  v_lshlrev_b32 v210, 16, v133
  v_lshlrev_b32 v212, 16, v134
  v_lshlrev_b32 v214, 16, v135
  v_and_b32 v209, v226, v132
  v_and_b32 v211, v226, v133
  v_and_b32 v213, v226, v134
  v_and_b32 v215, v226, v135
  v_pk_mul_f32 v[208:209], v[208:209], v[224:225]
  v_pk_mul_f32 v[210:211], v[210:211], v[224:225]
  v_pk_mul_f32 v[212:213], v[212:213], v[224:225]
  v_pk_mul_f32 v[214:215], v[214:215], v[224:225]
  v_cvt_pk_bf16_f32 v132, v208, v209
  v_cvt_pk_bf16_f32 v133, v210, v211
  v_cvt_pk_bf16_f32 v134, v212, v213
  v_cvt_pk_bf16_f32 v135, v214, v215
  v_dot2c_f32_bf16 v217, v132, v132
  v_dot2c_f32_bf16 v219, v133, v133
  v_dot2c_f32_bf16 v217, v134, v134
  v_dot2c_f32_bf16 v219, v135, v135
  ds_write_b128 v4, v[132:135] offset:8192
  s_nop 1
  v_add_f32 v217, v217, v219
  v_add_f32_dpp v216, v216, v216 quad_perm:[1,0,3,2] row_mask:0xf bank_mask:0xf
  s_nop 0
  v_add_f32_dpp v217, v217, v217 quad_perm:[1,0,3,2] row_mask:0xf bank_mask:0xf
  v_add_f32_dpp v216, v216, v216 quad_perm:[2,3,0,1] row_mask:0xf bank_mask:0xf
  s_nop 0
  v_add_f32_dpp v217, v217, v217 quad_perm:[2,3,0,1] row_mask:0xf bank_mask:0xf
  v_add_f32_dpp v216, v216, v216 row_half_mirror row_mask:0xf bank_mask:0xf
  s_nop 0
  v_add_f32_dpp v217, v217, v217 row_half_mirror row_mask:0xf bank_mask:0xf
  v_cvt_pk_bf16_f32 v216, 0, v216
  v_cvt_pk_bf16_f32 v217, 0, v217
  v_mul_f32 v216, -0.5, v216
  v_mul_f32 v217, -0.5, v217
  ds_write_b32 v5, v216 offset:1536
  ds_write_b32 v5, v217 offset:1568
  v_add_u32 v3, 12288, v3
  v_add_u32 v4, 12288, v4
  s_waitcnt lgkmcnt(0)
  s_barrier
  s_waitcnt vmcnt(12)
  v_mov_b32 v216, 0
  v_mov_b32 v218, 0
  v_lshlrev_b32 v208, 16, v136
  v_lshlrev_b32 v210, 16, v137
  v_lshlrev_b32 v212, 16, v138
  v_lshlrev_b32 v214, 16, v139
  v_and_b32 v209, v226, v136
  v_and_b32 v211, v226, v137
  v_and_b32 v213, v226, v138
  v_and_b32 v215, v226, v139
  v_pk_mul_f32 v[208:209], v[208:209], v[224:225]
  v_pk_mul_f32 v[210:211], v[210:211], v[224:225]
  v_pk_mul_f32 v[212:213], v[212:213], v[224:225]
  v_pk_mul_f32 v[214:215], v[214:215], v[224:225]
  v_cvt_pk_bf16_f32 v136, v208, v209
  v_cvt_pk_bf16_f32 v137, v210, v211
  v_cvt_pk_bf16_f32 v138, v212, v213
  v_cvt_pk_bf16_f32 v139, v214, v215
  v_dot2c_f32_bf16 v216, v136, v136
  v_dot2c_f32_bf16 v218, v137, v137
  v_dot2c_f32_bf16 v216, v138, v138
  v_dot2c_f32_bf16 v218, v139, v139
  ds_write_b128 v3, v[136:139] offset:0
  v_lshlrev_b32 v208, 16, v140
  v_lshlrev_b32 v210, 16, v141
  v_lshlrev_b32 v212, 16, v142
  v_lshlrev_b32 v214, 16, v143
  v_and_b32 v209, v226, v140
  v_and_b32 v211, v226, v141
  v_and_b32 v213, v226, v142
  v_and_b32 v215, v226, v143
  v_pk_mul_f32 v[208:209], v[208:209], v[224:225]
  v_pk_mul_f32 v[210:211], v[210:211], v[224:225]
  v_pk_mul_f32 v[212:213], v[212:213], v[224:225]
  v_pk_mul_f32 v[214:215], v[214:215], v[224:225]
  v_cvt_pk_bf16_f32 v140, v208, v209
  v_cvt_pk_bf16_f32 v141, v210, v211
  v_cvt_pk_bf16_f32 v142, v212, v213
  v_cvt_pk_bf16_f32 v143, v214, v215
  v_dot2c_f32_bf16 v216, v140, v140
  v_dot2c_f32_bf16 v218, v141, v141
  v_dot2c_f32_bf16 v216, v142, v142
  v_dot2c_f32_bf16 v218, v143, v143
  ds_write_b128 v3, v[140:143] offset:4096
  v_lshlrev_b32 v208, 16, v144
  v_lshlrev_b32 v210, 16, v145
  v_lshlrev_b32 v212, 16, v146
  v_lshlrev_b32 v214, 16, v147
  v_and_b32 v209, v226, v144
  v_and_b32 v211, v226, v145
  v_and_b32 v213, v226, v146
  v_and_b32 v215, v226, v147
  v_pk_mul_f32 v[208:209], v[208:209], v[224:225]
  v_pk_mul_f32 v[210:211], v[210:211], v[224:225]
  v_pk_mul_f32 v[212:213], v[212:213], v[224:225]
  v_pk_mul_f32 v[214:215], v[214:215], v[224:225]
  v_cvt_pk_bf16_f32 v144, v208, v209
  v_cvt_pk_bf16_f32 v145, v210, v211
  v_cvt_pk_bf16_f32 v146, v212, v213
  v_cvt_pk_bf16_f32 v147, v214, v215
  v_dot2c_f32_bf16 v216, v144, v144
  v_dot2c_f32_bf16 v218, v145, v145
  v_dot2c_f32_bf16 v216, v146, v146
  v_dot2c_f32_bf16 v218, v147, v147
  ds_write_b128 v3, v[144:147] offset:8192
  s_nop 1
  v_add_f32 v216, v216, v218
  v_mov_b32 v217, 0
  v_mov_b32 v219, 0
  v_lshlrev_b32 v208, 16, v148
  v_lshlrev_b32 v210, 16, v149
  v_lshlrev_b32 v212, 16, v150
  v_lshlrev_b32 v214, 16, v151
  v_and_b32 v209, v226, v148
  v_and_b32 v211, v226, v149
  v_and_b32 v213, v226, v150
  v_and_b32 v215, v226, v151
  v_pk_mul_f32 v[208:209], v[208:209], v[224:225]
  v_pk_mul_f32 v[210:211], v[210:211], v[224:225]
  v_pk_mul_f32 v[212:213], v[212:213], v[224:225]
  v_pk_mul_f32 v[214:215], v[214:215], v[224:225]
  v_cvt_pk_bf16_f32 v148, v208, v209
  v_cvt_pk_bf16_f32 v149, v210, v211
  v_cvt_pk_bf16_f32 v150, v212, v213
  v_cvt_pk_bf16_f32 v151, v214, v215
  v_dot2c_f32_bf16 v217, v148, v148
  v_dot2c_f32_bf16 v219, v149, v149
  v_dot2c_f32_bf16 v217, v150, v150
  v_dot2c_f32_bf16 v219, v151, v151
  ds_write_b128 v4, v[148:151] offset:0
  v_lshlrev_b32 v208, 16, v152
  v_lshlrev_b32 v210, 16, v153
  v_lshlrev_b32 v212, 16, v154
  v_lshlrev_b32 v214, 16, v155
  v_and_b32 v209, v226, v152
  v_and_b32 v211, v226, v153
  v_and_b32 v213, v226, v154
  v_and_b32 v215, v226, v155
  v_pk_mul_f32 v[208:209], v[208:209], v[224:225]
  v_pk_mul_f32 v[210:211], v[210:211], v[224:225]
  v_pk_mul_f32 v[212:213], v[212:213], v[224:225]
  v_pk_mul_f32 v[214:215], v[214:215], v[224:225]
  v_cvt_pk_bf16_f32 v152, v208, v209
  v_cvt_pk_bf16_f32 v153, v210, v211
  v_cvt_pk_bf16_f32 v154, v212, v213
  v_cvt_pk_bf16_f32 v155, v214, v215
  v_dot2c_f32_bf16 v217, v152, v152
  v_dot2c_f32_bf16 v219, v153, v153
  v_dot2c_f32_bf16 v217, v154, v154
  v_dot2c_f32_bf16 v219, v155, v155
  ds_write_b128 v4, v[152:155] offset:4096
  v_lshlrev_b32 v208, 16, v156
  v_lshlrev_b32 v210, 16, v157
  v_lshlrev_b32 v212, 16, v158
  v_lshlrev_b32 v214, 16, v159
  v_and_b32 v209, v226, v156
  v_and_b32 v211, v226, v157
  v_and_b32 v213, v226, v158
  v_and_b32 v215, v226, v159
  v_pk_mul_f32 v[208:209], v[208:209], v[224:225]
  v_pk_mul_f32 v[210:211], v[210:211], v[224:225]
  v_pk_mul_f32 v[212:213], v[212:213], v[224:225]
  v_pk_mul_f32 v[214:215], v[214:215], v[224:225]
  v_cvt_pk_bf16_f32 v156, v208, v209
  v_cvt_pk_bf16_f32 v157, v210, v211
  v_cvt_pk_bf16_f32 v158, v212, v213
  v_cvt_pk_bf16_f32 v159, v214, v215
  v_dot2c_f32_bf16 v217, v156, v156
  v_dot2c_f32_bf16 v219, v157, v157
  v_dot2c_f32_bf16 v217, v158, v158
  v_dot2c_f32_bf16 v219, v159, v159
  ds_write_b128 v4, v[156:159] offset:8192
  s_nop 1
  v_add_f32 v217, v217, v219
  v_add_f32_dpp v216, v216, v216 quad_perm:[1,0,3,2] row_mask:0xf bank_mask:0xf
  s_nop 0
  v_add_f32_dpp v217, v217, v217 quad_perm:[1,0,3,2] row_mask:0xf bank_mask:0xf
  v_add_f32_dpp v216, v216, v216 quad_perm:[2,3,0,1] row_mask:0xf bank_mask:0xf
  s_nop 0
  v_add_f32_dpp v217, v217, v217 quad_perm:[2,3,0,1] row_mask:0xf bank_mask:0xf
  v_add_f32_dpp v216, v216, v216 row_half_mirror row_mask:0xf bank_mask:0xf
  s_nop 0
  v_add_f32_dpp v217, v217, v217 row_half_mirror row_mask:0xf bank_mask:0xf
  v_cvt_pk_bf16_f32 v216, 0, v216
  v_cvt_pk_bf16_f32 v217, 0, v217
  v_mul_f32 v216, -0.5, v216
  v_mul_f32 v217, -0.5, v217
  ds_write_b32 v5, v216 offset:1664
  ds_write_b32 v5, v217 offset:1696
  v_add_u32 v3, 12288, v3
  v_add_u32 v4, 12288, v4
  s_waitcnt lgkmcnt(0)
  s_barrier
  s_waitcnt vmcnt(6)
  v_mov_b32 v216, 0
  v_mov_b32 v218, 0
  v_lshlrev_b32 v208, 16, v160
  v_lshlrev_b32 v210, 16, v161
  v_lshlrev_b32 v212, 16, v162
  v_lshlrev_b32 v214, 16, v163
  v_and_b32 v209, v226, v160
  v_and_b32 v211, v226, v161
  v_and_b32 v213, v226, v162
  v_and_b32 v215, v226, v163
  v_pk_mul_f32 v[208:209], v[208:209], v[224:225]
  v_pk_mul_f32 v[210:211], v[210:211], v[224:225]
  v_pk_mul_f32 v[212:213], v[212:213], v[224:225]
  v_pk_mul_f32 v[214:215], v[214:215], v[224:225]
  v_cvt_pk_bf16_f32 v160, v208, v209
  v_cvt_pk_bf16_f32 v161, v210, v211
  v_cvt_pk_bf16_f32 v162, v212, v213
  v_cvt_pk_bf16_f32 v163, v214, v215
  v_dot2c_f32_bf16 v216, v160, v160
  v_dot2c_f32_bf16 v218, v161, v161
  v_dot2c_f32_bf16 v216, v162, v162
  v_dot2c_f32_bf16 v218, v163, v163
  ds_write_b128 v3, v[160:163] offset:0
  v_lshlrev_b32 v208, 16, v164
  v_lshlrev_b32 v210, 16, v165
  v_lshlrev_b32 v212, 16, v166
  v_lshlrev_b32 v214, 16, v167
  v_and_b32 v209, v226, v164
  v_and_b32 v211, v226, v165
  v_and_b32 v213, v226, v166
  v_and_b32 v215, v226, v167
  v_pk_mul_f32 v[208:209], v[208:209], v[224:225]
  v_pk_mul_f32 v[210:211], v[210:211], v[224:225]
  v_pk_mul_f32 v[212:213], v[212:213], v[224:225]
  v_pk_mul_f32 v[214:215], v[214:215], v[224:225]
  v_cvt_pk_bf16_f32 v164, v208, v209
  v_cvt_pk_bf16_f32 v165, v210, v211
  v_cvt_pk_bf16_f32 v166, v212, v213
  v_cvt_pk_bf16_f32 v167, v214, v215
  v_dot2c_f32_bf16 v216, v164, v164
  v_dot2c_f32_bf16 v218, v165, v165
  v_dot2c_f32_bf16 v216, v166, v166
  v_dot2c_f32_bf16 v218, v167, v167
  ds_write_b128 v3, v[164:167] offset:4096
  v_lshlrev_b32 v208, 16, v168
  v_lshlrev_b32 v210, 16, v169
  v_lshlrev_b32 v212, 16, v170
  v_lshlrev_b32 v214, 16, v171
  v_and_b32 v209, v226, v168
  v_and_b32 v211, v226, v169
  v_and_b32 v213, v226, v170
  v_and_b32 v215, v226, v171
  v_pk_mul_f32 v[208:209], v[208:209], v[224:225]
  v_pk_mul_f32 v[210:211], v[210:211], v[224:225]
  v_pk_mul_f32 v[212:213], v[212:213], v[224:225]
  v_pk_mul_f32 v[214:215], v[214:215], v[224:225]
  v_cvt_pk_bf16_f32 v168, v208, v209
  v_cvt_pk_bf16_f32 v169, v210, v211
  v_cvt_pk_bf16_f32 v170, v212, v213
  v_cvt_pk_bf16_f32 v171, v214, v215
  v_dot2c_f32_bf16 v216, v168, v168
  v_dot2c_f32_bf16 v218, v169, v169
  v_dot2c_f32_bf16 v216, v170, v170
  v_dot2c_f32_bf16 v218, v171, v171
  ds_write_b128 v3, v[168:171] offset:8192
  s_nop 1
  v_add_f32 v216, v216, v218
  v_mov_b32 v217, 0
  v_mov_b32 v219, 0
  v_lshlrev_b32 v208, 16, v172
  v_lshlrev_b32 v210, 16, v173
  v_lshlrev_b32 v212, 16, v174
  v_lshlrev_b32 v214, 16, v175
  v_and_b32 v209, v226, v172
  v_and_b32 v211, v226, v173
  v_and_b32 v213, v226, v174
  v_and_b32 v215, v226, v175
  v_pk_mul_f32 v[208:209], v[208:209], v[224:225]
  v_pk_mul_f32 v[210:211], v[210:211], v[224:225]
  v_pk_mul_f32 v[212:213], v[212:213], v[224:225]
  v_pk_mul_f32 v[214:215], v[214:215], v[224:225]
  v_cvt_pk_bf16_f32 v172, v208, v209
  v_cvt_pk_bf16_f32 v173, v210, v211
  v_cvt_pk_bf16_f32 v174, v212, v213
  v_cvt_pk_bf16_f32 v175, v214, v215
  v_dot2c_f32_bf16 v217, v172, v172
  v_dot2c_f32_bf16 v219, v173, v173
  v_dot2c_f32_bf16 v217, v174, v174
  v_dot2c_f32_bf16 v219, v175, v175
  ds_write_b128 v4, v[172:175] offset:0
  v_lshlrev_b32 v208, 16, v176
  v_lshlrev_b32 v210, 16, v177
  v_lshlrev_b32 v212, 16, v178
  v_lshlrev_b32 v214, 16, v179
  v_and_b32 v209, v226, v176
  v_and_b32 v211, v226, v177
  v_and_b32 v213, v226, v178
  v_and_b32 v215, v226, v179
  v_pk_mul_f32 v[208:209], v[208:209], v[224:225]
  v_pk_mul_f32 v[210:211], v[210:211], v[224:225]
  v_pk_mul_f32 v[212:213], v[212:213], v[224:225]
  v_pk_mul_f32 v[214:215], v[214:215], v[224:225]
  v_cvt_pk_bf16_f32 v176, v208, v209
  v_cvt_pk_bf16_f32 v177, v210, v211
  v_cvt_pk_bf16_f32 v178, v212, v213
  v_cvt_pk_bf16_f32 v179, v214, v215
  v_dot2c_f32_bf16 v217, v176, v176
  v_dot2c_f32_bf16 v219, v177, v177
  v_dot2c_f32_bf16 v217, v178, v178
  v_dot2c_f32_bf16 v219, v179, v179
  ds_write_b128 v4, v[176:179] offset:4096
  v_lshlrev_b32 v208, 16, v180
  v_lshlrev_b32 v210, 16, v181
  v_lshlrev_b32 v212, 16, v182
  v_lshlrev_b32 v214, 16, v183
  v_and_b32 v209, v226, v180
  v_and_b32 v211, v226, v181
  v_and_b32 v213, v226, v182
  v_and_b32 v215, v226, v183
  v_pk_mul_f32 v[208:209], v[208:209], v[224:225]
  v_pk_mul_f32 v[210:211], v[210:211], v[224:225]
  v_pk_mul_f32 v[212:213], v[212:213], v[224:225]
  v_pk_mul_f32 v[214:215], v[214:215], v[224:225]
  v_cvt_pk_bf16_f32 v180, v208, v209
  v_cvt_pk_bf16_f32 v181, v210, v211
  v_cvt_pk_bf16_f32 v182, v212, v213
  v_cvt_pk_bf16_f32 v183, v214, v215
  v_dot2c_f32_bf16 v217, v180, v180
  v_dot2c_f32_bf16 v219, v181, v181
  v_dot2c_f32_bf16 v217, v182, v182
  v_dot2c_f32_bf16 v219, v183, v183
  ds_write_b128 v4, v[180:183] offset:8192
  s_nop 1
  v_add_f32 v217, v217, v219
  v_add_f32_dpp v216, v216, v216 quad_perm:[1,0,3,2] row_mask:0xf bank_mask:0xf
  s_nop 0
  v_add_f32_dpp v217, v217, v217 quad_perm:[1,0,3,2] row_mask:0xf bank_mask:0xf
  v_add_f32_dpp v216, v216, v216 quad_perm:[2,3,0,1] row_mask:0xf bank_mask:0xf
  s_nop 0
  v_add_f32_dpp v217, v217, v217 quad_perm:[2,3,0,1] row_mask:0xf bank_mask:0xf
  v_add_f32_dpp v216, v216, v216 row_half_mirror row_mask:0xf bank_mask:0xf
  s_nop 0
  v_add_f32_dpp v217, v217, v217 row_half_mirror row_mask:0xf bank_mask:0xf
  v_cvt_pk_bf16_f32 v216, 0, v216
  v_cvt_pk_bf16_f32 v217, 0, v217
  v_mul_f32 v216, -0.5, v216
  v_mul_f32 v217, -0.5, v217
  ds_write_b32 v5, v216 offset:1792
  ds_write_b32 v5, v217 offset:1824
  v_add_u32 v3, 12288, v3
  v_add_u32 v4, 12288, v4
  s_waitcnt lgkmcnt(0)
  s_barrier
  s_waitcnt vmcnt(0)
  v_mov_b32 v216, 0
  v_mov_b32 v218, 0
  v_lshlrev_b32 v208, 16, v184
  v_lshlrev_b32 v210, 16, v185
  v_lshlrev_b32 v212, 16, v186
  v_lshlrev_b32 v214, 16, v187
  v_and_b32 v209, v226, v184
  v_and_b32 v211, v226, v185
  v_and_b32 v213, v226, v186
  v_and_b32 v215, v226, v187
  v_pk_mul_f32 v[208:209], v[208:209], v[224:225]
  v_pk_mul_f32 v[210:211], v[210:211], v[224:225]
  v_pk_mul_f32 v[212:213], v[212:213], v[224:225]
  v_pk_mul_f32 v[214:215], v[214:215], v[224:225]
  v_cvt_pk_bf16_f32 v184, v208, v209
  v_cvt_pk_bf16_f32 v185, v210, v211
  v_cvt_pk_bf16_f32 v186, v212, v213
  v_cvt_pk_bf16_f32 v187, v214, v215
  v_dot2c_f32_bf16 v216, v184, v184
  v_dot2c_f32_bf16 v218, v185, v185
  v_dot2c_f32_bf16 v216, v186, v186
  v_dot2c_f32_bf16 v218, v187, v187
  ds_write_b128 v3, v[184:187] offset:0
  v_lshlrev_b32 v208, 16, v188
  v_lshlrev_b32 v210, 16, v189
  v_lshlrev_b32 v212, 16, v190
  v_lshlrev_b32 v214, 16, v191
  v_and_b32 v209, v226, v188
  v_and_b32 v211, v226, v189
  v_and_b32 v213, v226, v190
  v_and_b32 v215, v226, v191
  v_pk_mul_f32 v[208:209], v[208:209], v[224:225]
  v_pk_mul_f32 v[210:211], v[210:211], v[224:225]
  v_pk_mul_f32 v[212:213], v[212:213], v[224:225]
  v_pk_mul_f32 v[214:215], v[214:215], v[224:225]
  v_cvt_pk_bf16_f32 v188, v208, v209
  v_cvt_pk_bf16_f32 v189, v210, v211
  v_cvt_pk_bf16_f32 v190, v212, v213
  v_cvt_pk_bf16_f32 v191, v214, v215
  v_dot2c_f32_bf16 v216, v188, v188
  v_dot2c_f32_bf16 v218, v189, v189
  v_dot2c_f32_bf16 v216, v190, v190
  v_dot2c_f32_bf16 v218, v191, v191
  ds_write_b128 v3, v[188:191] offset:4096
  v_lshlrev_b32 v208, 16, v192
  v_lshlrev_b32 v210, 16, v193
  v_lshlrev_b32 v212, 16, v194
  v_lshlrev_b32 v214, 16, v195
  v_and_b32 v209, v226, v192
  v_and_b32 v211, v226, v193
  v_and_b32 v213, v226, v194
  v_and_b32 v215, v226, v195
  v_pk_mul_f32 v[208:209], v[208:209], v[224:225]
  v_pk_mul_f32 v[210:211], v[210:211], v[224:225]
  v_pk_mul_f32 v[212:213], v[212:213], v[224:225]
  v_pk_mul_f32 v[214:215], v[214:215], v[224:225]
  v_cvt_pk_bf16_f32 v192, v208, v209
  v_cvt_pk_bf16_f32 v193, v210, v211
  v_cvt_pk_bf16_f32 v194, v212, v213
  v_cvt_pk_bf16_f32 v195, v214, v215
  v_dot2c_f32_bf16 v216, v192, v192
  v_dot2c_f32_bf16 v218, v193, v193
  v_dot2c_f32_bf16 v216, v194, v194
  v_dot2c_f32_bf16 v218, v195, v195
  ds_write_b128 v3, v[192:195] offset:8192
  s_nop 1
  v_add_f32 v216, v216, v218
  v_mov_b32 v217, 0
  v_mov_b32 v219, 0
  v_lshlrev_b32 v208, 16, v196
  v_lshlrev_b32 v210, 16, v197
  v_lshlrev_b32 v212, 16, v198
  v_lshlrev_b32 v214, 16, v199
  v_and_b32 v209, v226, v196
  v_and_b32 v211, v226, v197
  v_and_b32 v213, v226, v198
  v_and_b32 v215, v226, v199
  v_pk_mul_f32 v[208:209], v[208:209], v[224:225]
  v_pk_mul_f32 v[210:211], v[210:211], v[224:225]
  v_pk_mul_f32 v[212:213], v[212:213], v[224:225]
  v_pk_mul_f32 v[214:215], v[214:215], v[224:225]
  v_cvt_pk_bf16_f32 v196, v208, v209
  v_cvt_pk_bf16_f32 v197, v210, v211
  v_cvt_pk_bf16_f32 v198, v212, v213
  v_cvt_pk_bf16_f32 v199, v214, v215
  v_dot2c_f32_bf16 v217, v196, v196
  v_dot2c_f32_bf16 v219, v197, v197
  v_dot2c_f32_bf16 v217, v198, v198
  v_dot2c_f32_bf16 v219, v199, v199
  ds_write_b128 v4, v[196:199] offset:0
  v_lshlrev_b32 v208, 16, v200
  v_lshlrev_b32 v210, 16, v201
  v_lshlrev_b32 v212, 16, v202
  v_lshlrev_b32 v214, 16, v203
  v_and_b32 v209, v226, v200
  v_and_b32 v211, v226, v201
  v_and_b32 v213, v226, v202
  v_and_b32 v215, v226, v203
  v_pk_mul_f32 v[208:209], v[208:209], v[224:225]
  v_pk_mul_f32 v[210:211], v[210:211], v[224:225]
  v_pk_mul_f32 v[212:213], v[212:213], v[224:225]
  v_pk_mul_f32 v[214:215], v[214:215], v[224:225]
  v_cvt_pk_bf16_f32 v200, v208, v209
  v_cvt_pk_bf16_f32 v201, v210, v211
  v_cvt_pk_bf16_f32 v202, v212, v213
  v_cvt_pk_bf16_f32 v203, v214, v215
  v_dot2c_f32_bf16 v217, v200, v200
  v_dot2c_f32_bf16 v219, v201, v201
  v_dot2c_f32_bf16 v217, v202, v202
  v_dot2c_f32_bf16 v219, v203, v203
  ds_write_b128 v4, v[200:203] offset:4096
  v_lshlrev_b32 v208, 16, v204
  v_lshlrev_b32 v210, 16, v205
  v_lshlrev_b32 v212, 16, v206
  v_lshlrev_b32 v214, 16, v207
  v_and_b32 v209, v226, v204
  v_and_b32 v211, v226, v205
  v_and_b32 v213, v226, v206
  v_and_b32 v215, v226, v207
  v_pk_mul_f32 v[208:209], v[208:209], v[224:225]
  v_pk_mul_f32 v[210:211], v[210:211], v[224:225]
  v_pk_mul_f32 v[212:213], v[212:213], v[224:225]
  v_pk_mul_f32 v[214:215], v[214:215], v[224:225]
  v_cvt_pk_bf16_f32 v204, v208, v209
  v_cvt_pk_bf16_f32 v205, v210, v211
  v_cvt_pk_bf16_f32 v206, v212, v213
  v_cvt_pk_bf16_f32 v207, v214, v215
  v_dot2c_f32_bf16 v217, v204, v204
  v_dot2c_f32_bf16 v219, v205, v205
  v_dot2c_f32_bf16 v217, v206, v206
  v_dot2c_f32_bf16 v219, v207, v207
  ds_write_b128 v4, v[204:207] offset:8192
  s_nop 1
  v_add_f32 v217, v217, v219
  v_add_f32_dpp v216, v216, v216 quad_perm:[1,0,3,2] row_mask:0xf bank_mask:0xf
  s_nop 0
  v_add_f32_dpp v217, v217, v217 quad_perm:[1,0,3,2] row_mask:0xf bank_mask:0xf
  v_add_f32_dpp v216, v216, v216 quad_perm:[2,3,0,1] row_mask:0xf bank_mask:0xf
  s_nop 0
  v_add_f32_dpp v217, v217, v217 quad_perm:[2,3,0,1] row_mask:0xf bank_mask:0xf
  v_add_f32_dpp v216, v216, v216 row_half_mirror row_mask:0xf bank_mask:0xf
  s_nop 0
  v_add_f32_dpp v217, v217, v217 row_half_mirror row_mask:0xf bank_mask:0xf
  v_cvt_pk_bf16_f32 v216, 0, v216
  v_cvt_pk_bf16_f32 v217, 0, v217
  v_mul_f32 v216, -0.5, v216
  v_mul_f32 v217, -0.5, v217
  ds_write_b32 v5, v216 offset:1920
  ds_write_b32 v5, v217 offset:1952
  v_add_u32 v3, 12288, v3
  v_add_u32 v4, 12288, v4
  s_waitcnt lgkmcnt(0)
  s_barrier
  v_lshlrev_b32 v11, 4, v1
  s_mul_i32 s58, s22, 73728
  s_add_u32 s58, s58, 26214400
  s_add_u32 s68, s20, s58
  s_addc_u32 s69, s21, 0
  s_and_b32 s69, s69, 0xffff
  s_mov_b32 s70, 73728
  s_mov_b32 s71, 0x20000
  s_barrier
  s_barrier
  s_mul_i32 s59, s24, 9216
  buffer_load_dwordx4 v[112:115], v11, s[68:71], s59 offen sc1
  s_add_u32 s59, s59, 1024
  buffer_load_dwordx4 v[116:119], v11, s[68:71], s59 offen sc1
  s_add_u32 s59, s59, 1024
  buffer_load_dwordx4 v[120:123], v11, s[68:71], s59 offen sc1
  s_add_u32 s59, s59, 1024
  buffer_load_dwordx4 v[124:127], v11, s[68:71], s59 offen sc1
  s_add_u32 s59, s59, 1024
  buffer_load_dwordx4 v[128:131], v11, s[68:71], s59 offen sc1
  s_add_u32 s59, s59, 1024
  buffer_load_dwordx4 v[132:135], v11, s[68:71], s59 offen sc1
  s_add_u32 s59, s59, 1024
  buffer_load_dwordx4 v[136:139], v11, s[68:71], s59 offen sc1
  s_add_u32 s59, s59, 1024
  buffer_load_dwordx4 v[140:143], v11, s[68:71], s59 offen sc1
  s_add_u32 s59, s59, 1024
  buffer_load_dwordx4 v[144:147], v11, s[68:71], s59 offen sc1
  s_cmp_eq_u32 s24, 6
  s_cbranch_scc0 L_pp6
  s_mul_i32 s57, s24, 12288
  v_add_u32 v13, s57, v11
  ds_read_b128 v[64:67], v13 offset:0
  ds_read_b128 v[68:71], v13 offset:1024
  ds_read_b128 v[72:75], v13 offset:2048
  ds_read_b128 v[76:79], v13 offset:3072
  ds_read_b128 v[80:83], v13 offset:4096
  ds_read_b128 v[84:87], v13 offset:5120
  ds_read_b128 v[88:91], v13 offset:6144
  ds_read_b128 v[92:95], v13 offset:7168
  ds_read_b128 v[96:99], v13 offset:8192
  ds_read_b128 v[100:103], v13 offset:9216
  ds_read_b128 v[104:107], v13 offset:10240
  ds_read_b128 v[108:111], v13 offset:11264
L_pp6:
  s_mul_i32 s58, s24, 9216
  v_add_u32 v148, s58, v11
  s_waitcnt vmcnt(8)
  ds_write_b128 v148, v[112:115] offset:0
  s_waitcnt vmcnt(7)
  ds_write_b128 v148, v[116:119] offset:1024
  s_waitcnt vmcnt(6)
  ds_write_b128 v148, v[120:123] offset:2048
  s_waitcnt vmcnt(5)
  ds_write_b128 v148, v[124:127] offset:3072
  s_waitcnt vmcnt(4)
  ds_write_b128 v148, v[128:131] offset:4096
  s_waitcnt vmcnt(3)
  ds_write_b128 v148, v[132:135] offset:5120
  s_waitcnt vmcnt(2)
  ds_write_b128 v148, v[136:139] offset:6144
  s_waitcnt vmcnt(1)
  ds_write_b128 v148, v[140:143] offset:7168
  s_waitcnt vmcnt(0)
  ds_write_b128 v148, v[144:147] offset:8192
  s_waitcnt lgkmcnt(0)
  s_branch L_fin
L_fin:
  s_barrier
  s_cmp_eq_u32 s24, 7
  s_cbranch_scc0 L_fpk
  s_mul_i32 s57, s24, 12288
  v_add_u32 v13, s57, v11
  ds_read_b128 v[64:67], v13 offset:0
  ds_read_b128 v[68:71], v13 offset:1024
  ds_read_b128 v[72:75], v13 offset:2048
  ds_read_b128 v[76:79], v13 offset:3072
  ds_read_b128 v[80:83], v13 offset:4096
  ds_read_b128 v[84:87], v13 offset:5120
  ds_read_b128 v[88:91], v13 offset:6144
  ds_read_b128 v[92:95], v13 offset:7168
  ds_read_b128 v[96:99], v13 offset:8192
  ds_read_b128 v[100:103], v13 offset:9216
  ds_read_b128 v[104:107], v13 offset:10240
  ds_read_b128 v[108:111], v13 offset:11264
  s_waitcnt lgkmcnt(0)
L_fpk:
  s_add_u32 s40, s16, s25
  s_addc_u32 s41, s17, 0
  s_and_b32 s41, s41, 0xffff
  s_mov_b32 s42, 98304
  s_mov_b32 s43, 0x20000
  v_and_b32 v2, 31, v1
  v_lshrrev_b32 v3, 5, v1
  v_lshlrev_b32 v5, 3, v3
  v_add_u32 v5, 137216, v5
  v_lshlrev_b32 v6, 4, v1
  s_lshl_b32 s57, s24, 12
  s_add_u32 s58, s57, 98304
  v_lshlrev_b32 v7, 7, v2
  v_lshl_add_u32 v7, v3, 3, v7
  v_add_u32 v7, s58, v7
  v_and_b32 v9, 7, v2
  v_lshrrev_b32 v10, 3, v1
  v_and_b32 v11, 7, v1
  v_xor_b32 v12, v11, v10
  v_lshlrev_b32 v8, 7, v10
  v_lshl_add_u32 v8, v12, 4, v8
  v_add_u32 v8, s58, v8
  s_lshl_b32 s57, s24, 5
  v_add_u32 v4, s57, v10
  v_mul_u32_u24 v4, 384, v4
  v_lshl_add_u32 v4, v11, 4, v4
  v_lshl_add_u32 v7, v9, 4, v7
  ds_read2_b64 v[144:147], v5 offset0:0 offset1:2
  ds_read2_b64 v[150:153], v5 offset0:4 offset1:6
  ds_read_b128 v[216:219], v6 offset:0
  ds_read_b128 v[220:223], v6 offset:1024
  ds_read_b128 v[224:227], v6 offset:2048
  ds_read_b128 v[228:231], v6 offset:3072
  ds_read_b128 v[232:235], v6 offset:4096
  ds_read_b128 v[236:239], v6 offset:5120
  ds_read_b128 v[240:243], v6 offset:6144
  v_xor_b32 v200, 16, v7
  v_xor_b32 v201, 32, v7
  v_xor_b32 v202, 48, v7
  v_xor_b32 v203, 64, v7
  v_xor_b32 v204, 80, v7
  v_xor_b32 v205, 96, v7
  v_xor_b32 v206, 112, v7
  s_cmp_lt_u32 s24, 6
  s_cbranch_scc1 L_noden
  s_waitcnt lgkmcnt(8)
  v_mfma_f32_32x32x16_bf16 v[160:175], v[144:147], v[64:67], 0
  ds_read2_b64 v[154:157], v5 offset0:8 offset1:10
  s_waitcnt lgkmcnt(8)
  v_mfma_f32_32x32x16_bf16 v[160:175], v[150:153], v[68:71], v[160:175]
  ds_read2_b64 v[144:147], v5 offset0:12 offset1:14
  s_waitcnt lgkmcnt(1)
  v_mfma_f32_32x32x16_bf16 v[160:175], v[154:157], v[72:75], v[160:175]
  ds_read2_b64 v[150:153], v5 offset0:16 offset1:18
  s_waitcnt lgkmcnt(1)
  v_mfma_f32_32x32x16_bf16 v[160:175], v[144:147], v[76:79], v[160:175]
  ds_read2_b64 v[154:157], v5 offset0:20 offset1:22
  s_waitcnt lgkmcnt(1)
  v_mfma_f32_32x32x16_bf16 v[160:175], v[150:153], v[80:83], v[160:175]
  ds_read2_b64 v[144:147], v5 offset0:24 offset1:26
  s_waitcnt lgkmcnt(1)
  v_mfma_f32_32x32x16_bf16 v[160:175], v[154:157], v[84:87], v[160:175]
  ds_read2_b64 v[150:153], v5 offset0:28 offset1:30
  s_waitcnt lgkmcnt(1)
  v_mfma_f32_32x32x16_bf16 v[160:175], v[144:147], v[88:91], v[160:175]
  ds_read2_b64 v[154:157], v5 offset0:32 offset1:34
  s_waitcnt lgkmcnt(1)
  v_mfma_f32_32x32x16_bf16 v[160:175], v[150:153], v[92:95], v[160:175]
  ds_read2_b64 v[144:147], v5 offset0:36 offset1:38
  s_waitcnt lgkmcnt(1)
  v_mfma_f32_32x32x16_bf16 v[160:175], v[154:157], v[96:99], v[160:175]
  ds_read2_b64 v[150:153], v5 offset0:40 offset1:42
  s_waitcnt lgkmcnt(1)
  v_mfma_f32_32x32x16_bf16 v[160:175], v[144:147], v[100:103], v[160:175]
  ds_read2_b64 v[154:157], v5 offset0:44 offset1:46
  s_waitcnt lgkmcnt(1)
  v_mfma_f32_32x32x16_bf16 v[160:175], v[150:153], v[104:107], v[160:175]
  s_waitcnt lgkmcnt(0)
  v_mfma_f32_32x32x16_bf16 v[160:175], v[154:157], v[108:111], v[160:175]
  s_nop 7
  s_nop 3
  v_add_f32 v149, 0x3549539c, v160
  v_rcp_f32 v149, v149
L_noden:
  s_waitcnt lgkmcnt(0)
  v_mfma_f32_32x32x16_bf16 v[112:127], v[216:219], v[64:67], 0
  ds_read_b128 v[244:247], v6 offset:7168
  v_mfma_f32_32x32x16_bf16 v[112:127], v[220:223], v[68:71], v[112:127]
  ds_read_b128 v[216:219], v6 offset:8192
  v_mfma_f32_32x32x16_bf16 v[112:127], v[224:227], v[72:75], v[112:127]
  ds_read_b128 v[220:223], v6 offset:9216
  v_mfma_f32_32x32x16_bf16 v[112:127], v[228:231], v[76:79], v[112:127]
  ds_read_b128 v[224:227], v6 offset:10240
  v_mfma_f32_32x32x16_bf16 v[112:127], v[232:235], v[80:83], v[112:127]
  ds_read_b128 v[228:231], v6 offset:11264
  v_mfma_f32_32x32x16_bf16 v[112:127], v[236:239], v[84:87], v[112:127]
  ds_read_b128 v[232:235], v6 offset:12288
  s_waitcnt lgkmcnt(4)
  v_mfma_f32_32x32x16_bf16 v[112:127], v[240:243], v[88:91], v[112:127]
  ds_read_b128 v[236:239], v6 offset:13312
  v_mfma_f32_32x32x16_bf16 v[112:127], v[244:247], v[92:95], v[112:127]
  ds_read_b128 v[240:243], v6 offset:14336
  v_mfma_f32_32x32x16_bf16 v[112:127], v[216:219], v[96:99], v[112:127]
  ds_read_b128 v[244:247], v6 offset:15360
  s_waitcnt lgkmcnt(4)
  v_mfma_f32_32x32x16_bf16 v[112:127], v[220:223], v[100:103], v[112:127]
  ds_read_b128 v[216:219], v6 offset:16384
  v_mfma_f32_32x32x16_bf16 v[112:127], v[224:227], v[104:107], v[112:127]
  ds_read_b128 v[220:223], v6 offset:17408
  v_mfma_f32_32x32x16_bf16 v[112:127], v[228:231], v[108:111], v[112:127]
  ds_read_b128 v[224:227], v6 offset:18432
  v_add_u32 v6, 12288, v6
  s_waitcnt lgkmcnt(4)
  v_mfma_f32_32x32x16_bf16 v[128:143], v[232:235], v[64:67], 0
  ds_read_b128 v[228:231], v6 offset:7168
  v_mfma_f32_32x32x16_bf16 v[128:143], v[236:239], v[68:71], v[128:143]
  ds_read_b128 v[232:235], v6 offset:8192
  s_nop 4
  v_mul_f32 v112, v112, v149
  v_mul_f32 v113, v113, v149
  v_mfma_f32_32x32x16_bf16 v[128:143], v[240:243], v[72:75], v[128:143]
  ds_read_b128 v[236:239], v6 offset:9216
  v_mul_f32 v114, v114, v149
  v_mul_f32 v115, v115, v149
  v_mul_f32 v116, v116, v149
  s_waitcnt lgkmcnt(4)
  v_mfma_f32_32x32x16_bf16 v[128:143], v[244:247], v[76:79], v[128:143]
  ds_read_b128 v[240:243], v6 offset:10240
  v_mul_f32 v117, v117, v149
  v_mul_f32 v118, v118, v149
  v_mfma_f32_32x32x16_bf16 v[128:143], v[216:219], v[80:83], v[128:143]
  ds_read_b128 v[244:247], v6 offset:11264
  v_mul_f32 v119, v119, v149
  v_mul_f32 v120, v120, v149
  v_mul_f32 v121, v121, v149
  v_mfma_f32_32x32x16_bf16 v[128:143], v[220:223], v[84:87], v[128:143]
  ds_read_b128 v[216:219], v6 offset:12288
  v_mul_f32 v122, v122, v149
  v_mul_f32 v123, v123, v149
  s_waitcnt lgkmcnt(4)
  v_mfma_f32_32x32x16_bf16 v[128:143], v[224:227], v[88:91], v[128:143]
  ds_read_b128 v[220:223], v6 offset:13312
  v_mul_f32 v124, v124, v149
  v_mul_f32 v125, v125, v149
  v_mul_f32 v126, v126, v149
  v_mfma_f32_32x32x16_bf16 v[128:143], v[228:231], v[92:95], v[128:143]
  ds_read_b128 v[224:227], v6 offset:14336
  v_mul_f32 v127, v127, v149
  v_cvt_pk_bf16_f32 v176, v112, v113
  v_mfma_f32_32x32x16_bf16 v[128:143], v[232:235], v[96:99], v[128:143]
  ds_read_b128 v[228:231], v6 offset:15360
  v_cvt_pk_bf16_f32 v177, v114, v115
  v_cvt_pk_bf16_f32 v178, v116, v117
  v_cvt_pk_bf16_f32 v179, v118, v119
  s_waitcnt lgkmcnt(4)
  v_mfma_f32_32x32x16_bf16 v[128:143], v[236:239], v[100:103], v[128:143]
  ds_read_b128 v[232:235], v6 offset:16384
  v_cvt_pk_bf16_f32 v180, v120, v121
  v_cvt_pk_bf16_f32 v181, v122, v123
  v_mfma_f32_32x32x16_bf16 v[128:143], v[240:243], v[104:107], v[128:143]
  ds_read_b128 v[236:239], v6 offset:17408
  v_cvt_pk_bf16_f32 v182, v124, v125
  v_cvt_pk_bf16_f32 v183, v126, v127
  ds_write_b64 v7, v[176:177]
  v_mfma_f32_32x32x16_bf16 v[128:143], v[244:247], v[108:111], v[128:143]
  ds_read_b128 v[240:243], v6 offset:18432
  ds_write_b64 v200, v[178:179]
  ds_write_b64 v201, v[180:181]
  ds_write_b64 v202, v[182:183]
  v_add_u32 v6, 12288, v6
  s_waitcnt lgkmcnt(8)
  v_mfma_f32_32x32x16_bf16 v[112:127], v[216:219], v[64:67], 0
  ds_read_b128 v[244:247], v6 offset:7168
  v_mfma_f32_32x32x16_bf16 v[112:127], v[220:223], v[68:71], v[112:127]
  ds_read_b128 v[216:219], v6 offset:8192
  s_nop 1
  v_mul_f32 v128, v128, v149
  v_mul_f32 v129, v129, v149
  v_mfma_f32_32x32x16_bf16 v[112:127], v[224:227], v[72:75], v[112:127]
  ds_read_b128 v[220:223], v6 offset:9216
  v_mul_f32 v130, v130, v149
  v_mul_f32 v131, v131, v149
  v_mul_f32 v132, v132, v149
  s_waitcnt lgkmcnt(8)
  v_mfma_f32_32x32x16_bf16 v[112:127], v[228:231], v[76:79], v[112:127]
  ds_read_b128 v[224:227], v6 offset:10240
  v_mul_f32 v133, v133, v149
  v_mul_f32 v134, v134, v149
  v_mul_f32 v135, v135, v149
  v_mfma_f32_32x32x16_bf16 v[112:127], v[232:235], v[80:83], v[112:127]
  ds_read_b128 v[228:231], v6 offset:11264
  v_mul_f32 v136, v136, v149
  v_mul_f32 v137, v137, v149
  v_mul_f32 v138, v138, v149
  v_mfma_f32_32x32x16_bf16 v[112:127], v[236:239], v[84:87], v[112:127]
  ds_read_b128 v[232:235], v6 offset:12288
  v_mul_f32 v139, v139, v149
  v_mul_f32 v140, v140, v149
  v_mul_f32 v141, v141, v149
  s_waitcnt lgkmcnt(4)
  v_mfma_f32_32x32x16_bf16 v[112:127], v[240:243], v[88:91], v[112:127]
  ds_read_b128 v[236:239], v6 offset:13312
  v_mul_f32 v142, v142, v149
  v_mul_f32 v143, v143, v149
  v_cvt_pk_bf16_f32 v176, v128, v129
  v_mfma_f32_32x32x16_bf16 v[112:127], v[244:247], v[92:95], v[112:127]
  ds_read_b128 v[240:243], v6 offset:14336
  v_cvt_pk_bf16_f32 v177, v130, v131
  v_cvt_pk_bf16_f32 v178, v132, v133
  v_cvt_pk_bf16_f32 v179, v134, v135
  v_mfma_f32_32x32x16_bf16 v[112:127], v[216:219], v[96:99], v[112:127]
  ds_read_b128 v[244:247], v6 offset:15360
  v_cvt_pk_bf16_f32 v180, v136, v137
  v_cvt_pk_bf16_f32 v181, v138, v139
  v_cvt_pk_bf16_f32 v182, v140, v141
  s_waitcnt lgkmcnt(4)
  v_mfma_f32_32x32x16_bf16 v[112:127], v[220:223], v[100:103], v[112:127]
  ds_read_b128 v[216:219], v6 offset:16384
  v_cvt_pk_bf16_f32 v183, v142, v143
  ds_write_b64 v203, v[176:177]
  ds_write_b64 v204, v[178:179]
  v_mfma_f32_32x32x16_bf16 v[112:127], v[224:227], v[104:107], v[112:127]
  ds_read_b128 v[220:223], v6 offset:17408
  ds_write_b64 v205, v[180:181]
  ds_write_b64 v206, v[182:183]
  ds_read_b128 v[184:187], v8 offset:0
  v_mfma_f32_32x32x16_bf16 v[112:127], v[228:231], v[108:111], v[112:127]
  ds_read_b128 v[224:227], v6 offset:18432
  ds_read_b128 v[188:191], v8 offset:1024
  ds_read_b128 v[192:195], v8 offset:2048
  ds_read_b128 v[196:199], v8 offset:3072
  v_add_u32 v6, 12288, v6
  s_waitcnt lgkmcnt(12)
  v_mfma_f32_32x32x16_bf16 v[128:143], v[232:235], v[64:67], 0
  ds_read_b128 v[228:231], v6 offset:7168
  v_mfma_f32_32x32x16_bf16 v[128:143], v[236:239], v[68:71], v[128:143]
  ds_read_b128 v[232:235], v6 offset:8192
  s_nop 1
  v_mul_f32 v112, v112, v149
  v_mul_f32 v113, v113, v149
  v_mfma_f32_32x32x16_bf16 v[128:143], v[240:243], v[72:75], v[128:143]
  ds_read_b128 v[236:239], v6 offset:9216
  s_waitcnt lgkmcnt(7)
  s_mov_b32 s56, 0
  buffer_store_dwordx4 v[184:187], v4, s[40:43], s56 offen sc1
  v_mul_f32 v114, v114, v149
  v_mul_f32 v115, v115, v149
  v_mul_f32 v116, v116, v149
  v_mfma_f32_32x32x16_bf16 v[128:143], v[244:247], v[76:79], v[128:143]
  ds_read_b128 v[240:243], v6 offset:10240
  s_waitcnt lgkmcnt(6)
  s_mov_b32 s56, 3072
  buffer_store_dwordx4 v[188:191], v4, s[40:43], s56 offen sc1
  v_mul_f32 v117, v117, v149
  v_mul_f32 v118, v118, v149
  v_mfma_f32_32x32x16_bf16 v[128:143], v[216:219], v[80:83], v[128:143]
  ds_read_b128 v[244:247], v6 offset:11264
  s_waitcnt lgkmcnt(6)
  s_mov_b32 s56, 6144
  buffer_store_dwordx4 v[192:195], v4, s[40:43], s56 offen sc1
  v_mul_f32 v119, v119, v149
  v_mul_f32 v120, v120, v149
  v_mul_f32 v121, v121, v149
  v_mfma_f32_32x32x16_bf16 v[128:143], v[220:223], v[84:87], v[128:143]
  ds_read_b128 v[216:219], v6 offset:12288
  s_waitcnt lgkmcnt(6)
  s_mov_b32 s56, 9216
  buffer_store_dwordx4 v[196:199], v4, s[40:43], s56 offen sc1
  v_mul_f32 v122, v122, v149
  v_mul_f32 v123, v123, v149
  s_waitcnt lgkmcnt(4)
  v_mfma_f32_32x32x16_bf16 v[128:143], v[224:227], v[88:91], v[128:143]
  ds_read_b128 v[220:223], v6 offset:13312
  v_mul_f32 v124, v124, v149
  v_mul_f32 v125, v125, v149
  v_mul_f32 v126, v126, v149
  v_mfma_f32_32x32x16_bf16 v[128:143], v[228:231], v[92:95], v[128:143]
  ds_read_b128 v[224:227], v6 offset:14336
  v_mul_f32 v127, v127, v149
  v_cvt_pk_bf16_f32 v176, v112, v113
  v_mfma_f32_32x32x16_bf16 v[128:143], v[232:235], v[96:99], v[128:143]
  ds_read_b128 v[228:231], v6 offset:15360
  v_cvt_pk_bf16_f32 v177, v114, v115
  v_cvt_pk_bf16_f32 v178, v116, v117
  v_cvt_pk_bf16_f32 v179, v118, v119
  s_waitcnt lgkmcnt(4)
  v_mfma_f32_32x32x16_bf16 v[128:143], v[236:239], v[100:103], v[128:143]
  ds_read_b128 v[232:235], v6 offset:16384
  v_cvt_pk_bf16_f32 v180, v120, v121
  v_cvt_pk_bf16_f32 v181, v122, v123
  v_mfma_f32_32x32x16_bf16 v[128:143], v[240:243], v[104:107], v[128:143]
  ds_read_b128 v[236:239], v6 offset:17408
  v_cvt_pk_bf16_f32 v182, v124, v125
  v_cvt_pk_bf16_f32 v183, v126, v127
  ds_write_b64 v7, v[176:177]
  v_mfma_f32_32x32x16_bf16 v[128:143], v[244:247], v[108:111], v[128:143]
  ds_read_b128 v[240:243], v6 offset:18432
  ds_write_b64 v200, v[178:179]
  ds_write_b64 v201, v[180:181]
  ds_write_b64 v202, v[182:183]
  v_add_u32 v6, 12288, v6
  s_waitcnt lgkmcnt(8)
  v_mfma_f32_32x32x16_bf16 v[112:127], v[216:219], v[64:67], 0
  ds_read_b128 v[244:247], v6 offset:7168
  v_mfma_f32_32x32x16_bf16 v[112:127], v[220:223], v[68:71], v[112:127]
  ds_read_b128 v[216:219], v6 offset:8192
  s_nop 1
  v_mul_f32 v128, v128, v149
  v_mul_f32 v129, v129, v149
  v_mfma_f32_32x32x16_bf16 v[112:127], v[224:227], v[72:75], v[112:127]
  ds_read_b128 v[220:223], v6 offset:9216
  v_mul_f32 v130, v130, v149
  v_mul_f32 v131, v131, v149
  v_mul_f32 v132, v132, v149
  s_waitcnt lgkmcnt(8)
  v_mfma_f32_32x32x16_bf16 v[112:127], v[228:231], v[76:79], v[112:127]
  ds_read_b128 v[224:227], v6 offset:10240
  v_mul_f32 v133, v133, v149
  v_mul_f32 v134, v134, v149
  v_mul_f32 v135, v135, v149
  v_mfma_f32_32x32x16_bf16 v[112:127], v[232:235], v[80:83], v[112:127]
  ds_read_b128 v[228:231], v6 offset:11264
  v_mul_f32 v136, v136, v149
  v_mul_f32 v137, v137, v149
  v_mul_f32 v138, v138, v149
  v_mfma_f32_32x32x16_bf16 v[112:127], v[236:239], v[84:87], v[112:127]
  ds_read_b128 v[232:235], v6 offset:12288
  v_mul_f32 v139, v139, v149
  v_mul_f32 v140, v140, v149
  v_mul_f32 v141, v141, v149
  s_waitcnt lgkmcnt(4)
  v_mfma_f32_32x32x16_bf16 v[112:127], v[240:243], v[88:91], v[112:127]
  ds_read_b128 v[236:239], v6 offset:13312
  v_mul_f32 v142, v142, v149
  v_mul_f32 v143, v143, v149
  v_cvt_pk_bf16_f32 v176, v128, v129
  v_mfma_f32_32x32x16_bf16 v[112:127], v[244:247], v[92:95], v[112:127]
  ds_read_b128 v[240:243], v6 offset:14336
  v_cvt_pk_bf16_f32 v177, v130, v131
  v_cvt_pk_bf16_f32 v178, v132, v133
  v_cvt_pk_bf16_f32 v179, v134, v135
  v_mfma_f32_32x32x16_bf16 v[112:127], v[216:219], v[96:99], v[112:127]
  ds_read_b128 v[244:247], v6 offset:15360
  v_cvt_pk_bf16_f32 v180, v136, v137
  v_cvt_pk_bf16_f32 v181, v138, v139
  v_cvt_pk_bf16_f32 v182, v140, v141
  s_waitcnt lgkmcnt(4)
  v_mfma_f32_32x32x16_bf16 v[112:127], v[220:223], v[100:103], v[112:127]
  ds_read_b128 v[216:219], v6 offset:16384
  v_cvt_pk_bf16_f32 v183, v142, v143
  ds_write_b64 v203, v[176:177]
  ds_write_b64 v204, v[178:179]
  v_mfma_f32_32x32x16_bf16 v[112:127], v[224:227], v[104:107], v[112:127]
  ds_read_b128 v[220:223], v6 offset:17408
  ds_write_b64 v205, v[180:181]
  ds_write_b64 v206, v[182:183]
  ds_read_b128 v[184:187], v8 offset:0
  v_mfma_f32_32x32x16_bf16 v[112:127], v[228:231], v[108:111], v[112:127]
  ds_read_b128 v[224:227], v6 offset:18432
  ds_read_b128 v[188:191], v8 offset:1024
  ds_read_b128 v[192:195], v8 offset:2048
  ds_read_b128 v[196:199], v8 offset:3072
  v_add_u32 v6, 12288, v6
  s_waitcnt lgkmcnt(12)
  v_mfma_f32_32x32x16_bf16 v[128:143], v[232:235], v[64:67], 0
  ds_read_b128 v[228:231], v6 offset:7168
  v_mfma_f32_32x32x16_bf16 v[128:143], v[236:239], v[68:71], v[128:143]
  ds_read_b128 v[232:235], v6 offset:8192
  s_nop 1
  v_mul_f32 v112, v112, v149
  v_mul_f32 v113, v113, v149
  v_mfma_f32_32x32x16_bf16 v[128:143], v[240:243], v[72:75], v[128:143]
  ds_read_b128 v[236:239], v6 offset:9216
  s_waitcnt lgkmcnt(7)
  s_mov_b32 s56, 128
  buffer_store_dwordx4 v[184:187], v4, s[40:43], s56 offen sc1
  v_mul_f32 v114, v114, v149
  v_mul_f32 v115, v115, v149
  v_mul_f32 v116, v116, v149
  v_mfma_f32_32x32x16_bf16 v[128:143], v[244:247], v[76:79], v[128:143]
  ds_read_b128 v[240:243], v6 offset:10240
  s_waitcnt lgkmcnt(6)
  s_mov_b32 s56, 3200
  buffer_store_dwordx4 v[188:191], v4, s[40:43], s56 offen sc1
  v_mul_f32 v117, v117, v149
  v_mul_f32 v118, v118, v149
  v_mfma_f32_32x32x16_bf16 v[128:143], v[216:219], v[80:83], v[128:143]
  ds_read_b128 v[244:247], v6 offset:11264
  s_waitcnt lgkmcnt(6)
  s_mov_b32 s56, 6272
  buffer_store_dwordx4 v[192:195], v4, s[40:43], s56 offen sc1
  v_mul_f32 v119, v119, v149
  v_mul_f32 v120, v120, v149
  v_mul_f32 v121, v121, v149
  v_mfma_f32_32x32x16_bf16 v[128:143], v[220:223], v[84:87], v[128:143]
  s_waitcnt lgkmcnt(5)
  s_mov_b32 s56, 9344
  buffer_store_dwordx4 v[196:199], v4, s[40:43], s56 offen sc1
  v_mul_f32 v122, v122, v149
  v_mul_f32 v123, v123, v149
  s_waitcnt lgkmcnt(3)
  v_mfma_f32_32x32x16_bf16 v[128:143], v[224:227], v[88:91], v[128:143]
  v_mul_f32 v124, v124, v149
  v_mul_f32 v125, v125, v149
  v_mul_f32 v126, v126, v149
  v_mfma_f32_32x32x16_bf16 v[128:143], v[228:231], v[92:95], v[128:143]
  v_mul_f32 v127, v127, v149
  v_cvt_pk_bf16_f32 v176, v112, v113
  v_mfma_f32_32x32x16_bf16 v[128:143], v[232:235], v[96:99], v[128:143]
  v_cvt_pk_bf16_f32 v177, v114, v115
  v_cvt_pk_bf16_f32 v178, v116, v117
  v_cvt_pk_bf16_f32 v179, v118, v119
  s_waitcnt lgkmcnt(0)
  v_mfma_f32_32x32x16_bf16 v[128:143], v[236:239], v[100:103], v[128:143]
  v_cvt_pk_bf16_f32 v180, v120, v121
  v_cvt_pk_bf16_f32 v181, v122, v123
  v_mfma_f32_32x32x16_bf16 v[128:143], v[240:243], v[104:107], v[128:143]
  v_cvt_pk_bf16_f32 v182, v124, v125
  v_cvt_pk_bf16_f32 v183, v126, v127
  ds_write_b64 v7, v[176:177]
  v_mfma_f32_32x32x16_bf16 v[128:143], v[244:247], v[108:111], v[128:143]
  ds_write_b64 v200, v[178:179]
  ds_write_b64 v201, v[180:181]
  ds_write_b64 v202, v[182:183]
  s_nop 8
  v_mul_f32 v128, v128, v149
  v_mul_f32 v129, v129, v149
  v_mul_f32 v130, v130, v149
  v_mul_f32 v131, v131, v149
  v_mul_f32 v132, v132, v149
  v_mul_f32 v133, v133, v149
  v_mul_f32 v134, v134, v149
  v_mul_f32 v135, v135, v149
  v_mul_f32 v136, v136, v149
  v_mul_f32 v137, v137, v149
  v_mul_f32 v138, v138, v149
  v_mul_f32 v139, v139, v149
  v_mul_f32 v140, v140, v149
  v_mul_f32 v141, v141, v149
  v_mul_f32 v142, v142, v149
  v_mul_f32 v143, v143, v149
  v_cvt_pk_bf16_f32 v176, v128, v129
  v_cvt_pk_bf16_f32 v177, v130, v131
  v_cvt_pk_bf16_f32 v178, v132, v133
  v_cvt_pk_bf16_f32 v179, v134, v135
  v_cvt_pk_bf16_f32 v180, v136, v137
  v_cvt_pk_bf16_f32 v181, v138, v139
  v_cvt_pk_bf16_f32 v182, v140, v141
  v_cvt_pk_bf16_f32 v183, v142, v143
  ds_write_b64 v203, v[176:177]
  ds_write_b64 v204, v[178:179]
  ds_write_b64 v205, v[180:181]
  ds_write_b64 v206, v[182:183]
  ds_read_b128 v[184:187], v8 offset:0
  ds_read_b128 v[188:191], v8 offset:1024
  ds_read_b128 v[192:195], v8 offset:2048
  ds_read_b128 v[196:199], v8 offset:3072
  s_waitcnt lgkmcnt(3)
  s_mov_b32 s56, 256
  buffer_store_dwordx4 v[184:187], v4, s[40:43], s56 offen sc1
  s_waitcnt lgkmcnt(2)
  s_mov_b32 s56, 3328
  buffer_store_dwordx4 v[188:191], v4, s[40:43], s56 offen sc1
  s_waitcnt lgkmcnt(1)
  s_mov_b32 s56, 6400
  buffer_store_dwordx4 v[192:195], v4, s[40:43], s56 offen sc1
  s_waitcnt lgkmcnt(0)
  s_mov_b32 s56, 9472
  buffer_store_dwordx4 v[196:199], v4, s[40:43], s56 offen sc1
  s_waitcnt lgkmcnt(0)
L_end:
  s_endpgm
.section .rodata,"a"
.p2align 6
.amdhsa_kernel standalone__linear_kernel_performer__prompt_kernel
  .amdhsa_next_free_vgpr 256
  .amdhsa_next_free_sgpr 102
  .amdhsa_accum_offset 256
  .amdhsa_group_segment_fixed_size 0
  .amdhsa_kernarg_size 56
  .amdhsa_user_sgpr_count 2
  .amdhsa_user_sgpr_kernarg_segment_ptr 1
  .amdhsa_system_sgpr_workgroup_id_x 1
  .amdhsa_float_denorm_mode_32 3
.end_amdhsa_kernel
```
